```python
import torch

def _softmax(x, axis=-1):
    return torch.softmax(x, dim=axis)
def _gelu(x):
    return torch.nn.functional.gelu(x, approximate="tanh")
def _silu(x):
    return torch.nn.functional.silu(x)
def _sigmoid(x):
    return torch.sigmoid(x)
def _layernorm(x, axis=-1, eps=1e-5):
    m = x.mean(dim=axis, keepdim=True)
    v = x.var(dim=axis, keepdim=True, unbiased=False)
    return (x - m) / torch.sqrt(v + eps)
def _scatter_add(tgt, idx, src, axis=0):
    return tgt.clone().index_add_(axis, idx, src)
def _segment_sum(src, seg, n):
    out = torch.zeros((n,) + src.shape[1:], dtype=src.dtype)
    return out.index_add_(0, seg, src)
def _pad(x, pw):
    flat = tuple(v for pair in reversed(pw) for v in pair)
    return torch.nn.functional.pad(x, flat)

kernel_name = 'gated_mix__gqa_block_cached__compressed_kv_cla__decode'

def setup_inputs():

    _w = (lambda a: (lambda t: t.to(torch.bfloat16) if t.is_floating_point() else t)(torch.as_tensor(a)))
    def _A_setup():
        B, Sq, D = 2, 1, 576
        Hq, Hkv, Sk, Dh = 32, 16, 8192, 128
        assert Hq % Hkv == 0, (Hq, Hkv)
        return {
            "x": _w((lambda *s: torch.randn(*s, dtype=torch.bfloat16) * 0.05)(B, Sq, D)),
            "k_cache": _w((lambda *s: torch.randn(*s, dtype=torch.bfloat16) * 6.4)(B, Hkv, Sk, Dh)),
            "v_cache": _w((lambda *s: torch.randn(*s, dtype=torch.bfloat16) * 0.8)(B, Hkv, Sk, Dh)),
            "wq": _w((lambda *s: torch.randn(*s, dtype=torch.bfloat16) * 6.4)(D, Hq * Dh) * (D ** -0.5)),
            "wo": _w((lambda *s: torch.randn(*s, dtype=torch.bfloat16) * 0.8)(Hq * Dh, D) * ((Hq * Dh) ** -0.5)),
        }
    _A_in = _A_setup()

    def _B_setup():
        B, H, Sq, Sk, D, M = 2, 32, 1, 8192, 128, 576
        Dc = 4 * D
        return {
            "x": _w((lambda *s: torch.randn(*s, dtype=torch.bfloat16) * 0.05)(B, Sq, M)),
            "c_kv": _w((lambda *s: torch.randn(*s, dtype=torch.bfloat16) * 1.6)(B, Sk, Dc)),
            "w_q": _w((lambda *s: torch.randn(*s, dtype=torch.bfloat16) * 3.2)(M, H, D) * (M ** -0.5)),
            "w_uk": _w((lambda *s: torch.randn(*s, dtype=torch.bfloat16) * 3.2)(Dc, H, D) * (Dc ** -0.5)),
            "w_uv": _w((lambda *s: torch.randn(*s, dtype=torch.bfloat16) * 1.6)(Dc, H, D) * (Dc ** -0.5)),
            "w_o": _w((lambda *s: torch.randn(*s, dtype=torch.bfloat16) * 1.6)(H, D, M) * ((H * D) ** -0.5)),
        }
    _B_in = _B_setup()

    return {
        "A_x": _A_in["x"],
        "A_k_cache": _A_in["k_cache"],
        "A_v_cache": _A_in["v_cache"],
        "A_wq": _A_in["wq"],
        "A_wo": _A_in["wo"],
        "B_x": _B_in["x"],
        "B_c_kv": _B_in["c_kv"],
        "B_w_q": _B_in["w_q"],
        "B_w_uk": _B_in["w_uk"],
        "B_w_uv": _B_in["w_uv"],
        "B_w_o": _B_in["w_o"],
        "gate_w": _w((lambda *s: torch.randn(*s, dtype=torch.bfloat16) * 0.05)(576) * 16.0),
    }

def reference(A_x, A_k_cache, A_v_cache, A_wq, A_wo, B_x, B_c_kv, B_w_q, B_w_uk, B_w_uv, B_w_o, gate_w):
    def _A_ref(x, k_cache, v_cache, wq, wo):
        B, Sq, D = x.shape
        Hq, Dh = 32, 128
        Hkv = k_cache.shape[1]
        rep = Hq // Hkv
        q = (lambda x, *d: x.permute(*d))((x @ wq).reshape(B, Sq, Hq, Dh), 0, 2, 1, 3)
        k = (lambda x, n, axis: torch.repeat_interleave(x, n, dim=axis))(k_cache, rep, axis=1)
        v = (lambda x, n, axis: torch.repeat_interleave(x, n, dim=axis))(v_cache, rep, axis=1)
        scores = torch.einsum("bhqd,bhkd->bhqk", q, k) * (Dh ** -0.5)
        p = _softmax(scores, axis=-1)
        o = torch.einsum("bhqk,bhkd->bhqd", p, v)
        return (lambda x, *d: x.permute(*d))(o, 0, 2, 1, 3).reshape(B, Sq, Hq * Dh) @ wo

    def _B_ref(x, c_kv, w_q, w_uk, w_uv, w_o):
        B, Sq, M = x.shape[0], x.shape[1], x.shape[2]
        Sk = c_kv.shape[1]
        H, D = w_q.shape[1], w_q.shape[2]
        q = torch.einsum("bqm,mhd->bhqd", x, w_q)
        k = torch.einsum("bkc,chd->bhkd", c_kv, w_uk)
        v = torch.einsum("bkc,chd->bhkd", c_kv, w_uv)
        scores = torch.einsum("bhqd,bhkd->bhqk", q, k) * (D ** -0.5)
        off = Sk - Sq
        qi = torch.arange(Sq)[:, None]
        kj = torch.arange(Sk)[None, :]
        cmask = kj <= (qi + off)
        scores = torch.where(cmask[None, None], scores, -1e9)
        p = _softmax(scores, axis=-1)
        ctx = torch.einsum("bhqk,bhkd->bhqd", p, v)
        return torch.einsum("bhqd,hdm->bqm", ctx, w_o)

    x = A_x
    g = _sigmoid((x * gate_w).sum(-1, keepdims=True))
    a = _A_ref(x, A_k_cache, A_v_cache, A_wq, A_wo)
    b = _B_ref(x, B_c_kv, B_w_q, B_w_uk, B_w_uv, B_w_o)
    return g * a + (1 - g) * b
```

```asm
; @launch grid=(256,1,1) block=(512,1,1) lds=163840
.amdgcn_target "amdgcn-amd-amdhsa--gfx950"
.text
.globl gated_mix__gqa_block_cached__compressed_kv_cla__decode_kernel
.p2align 8
.type gated_mix__gqa_block_cached__compressed_kv_cla__decode_kernel,@function
gated_mix__gqa_block_cached__compressed_kv_cla__decode_kernel:
    s_cmp_ge_u32 s2, 256
    s_cbranch_scc1 L_end_6
    s_load_dwordx16 s[4:19], s[0:1], 0
    s_load_dwordx8 s[20:27], s[0:1], 64
    s_load_dwordx4 s[28:31], s[0:1], 96
    s_load_dwordx2 s[32:33], s[0:1], 112
    v_lshrrev_b32 v1, 6, v0
    v_and_b32 v0, 63, v0
    v_readfirstlane_b32 s3, v1
    v_lshlrev_b32 v1, 4, v0
    s_cmp_lt_u32 s2, 64
    s_cbranch_scc1 L_eh_11
    s_sub_u32 s48, s2, 64
    s_mul_i32 s49, s48, 171
    s_lshr_b32 s49, s49, 12
    s_mul_i32 s52, s49, 24
    s_sub_u32 s52, s48, s52
    s_lshr_b32 s54, s52, 3
    s_bfe_u32 s55, s52, 0x10002
    s_add_u32 s52, s52, s54
    s_add_u32 s52, s52, 1
    s_and_b32 s52, s52, 3
    s_lshl_b32 s49, s49, 2
    s_add_u32 s49, s49, s52
    s_lshl_b32 s50, s54, 1
    s_add_u32 s50, s50, s55
    s_lshl_b32 s57, s49, 1
    s_cmp_eq_u32 s54, 2
    s_cselect_b32 s66, 2, s55
    s_cselect_b32 s52, s55, s54
    s_add_u32 s57, s57, s52
    s_cmp_eq_u32 s66, 2
    s_cbranch_scc1 L_e2_10
    v_lshrrev_b32 v48, 4, v0
    v_mul_u32_u24 v49, 18, v48
    v_bfe_u32 v50, v0, 3, 1
    v_add_u32 v51, v49, v50
    s_mul_i32 s52, s3, 72
    v_add_u32 v51, s52, v51
    v_lshlrev_b32 v28, 13, v51
    v_and_b32 v51, 7, v0
    v_lshl_add_u32 v28, v51, 4, v28
    s_lshl_b32 s54, s57, 7
    v_add_u32 v28, s54, v28
    v_lshlrev_b32 v62, 3, v0
    v_add_u32 v51, 1008, v62
    v_cmp_lt_u32 vcc, 17, v0
    s_lshl_b32 s52, s52, 1
    v_mov_b32 v52, 0x10000
    v_cndmask_b32 v63, v62, v51, vcc
    v_cmp_lt_u32 vcc, 35, v0
    v_add_u32 v63, s52, v63
    s_cmp_eq_u32 s66, 0
    v_cndmask_b32 v63, v63, v52, vcc
    s_waitcnt lgkmcnt(0)
    s_cselect_b32 s54, s18, s10
    s_cselect_b32 s55, s19, s11
    s_mov_b32 s72, s54
    s_and_b32 s73, s55, 0xffff
    s_mov_b32 s74, 4718592
    s_mov_b32 s75, 0x20000
    s_mov_b32 s76, s4
    s_and_b32 s77, s5, 0xffff
    s_mov_b32 s78, 2304
    s_mov_b32 s79, 0x20000
    buffer_load_dwordx2 v[20:21], v63, s[76:79], 0 offen
    s_mov_b32 s51, 0
    buffer_load_dwordx4 v[212:215], v28, s[72:75], s51 offen nt
    s_mov_b32 s51, 16384
    buffer_load_dwordx4 v[216:219], v28, s[72:75], s51 offen nt
    s_cmp_lg_u32 s66, 0
    s_cbranch_scc1 L_headq_1
    s_mov_b32 s51, 32768
    buffer_load_dwordx4 v[220:223], v28, s[72:75], s51 offen nt
    s_mov_b32 s51, 49152
    buffer_load_dwordx4 v[224:227], v28, s[72:75], s51 offen nt
    s_branch L_headq_1
L_e2_10:
    s_lshr_b32 s56, s57, 4
    s_and_b32 s52, s57, 15
    s_lshl_b32 s52, s52, 2
    s_lshr_b32 s54, s3, 1
    s_add_u32 s52, s52, s54
    s_lshl_b32 s52, s52, 16
    s_lshl_b32 s54, s56, 1
    s_and_b32 s55, s3, 1
    s_add_u32 s54, s54, s55
    s_lshl_b32 s55, s54, 10
    s_add_u32 s52, s52, s55
    v_add_u32 v28, s52, v1
    s_waitcnt lgkmcnt(0)
    s_mov_b32 s72, s20
    s_and_b32 s73, s21, 0xffff
    s_mov_b32 s74, 4194304
    s_mov_b32 s75, 0x20000
    s_mov_b32 s51, 0
    buffer_load_dwordx4 v[216:219], v28, s[72:75], s51 offen nt
    s_mov_b32 s51, 8192
    buffer_load_dwordx4 v[220:223], v28, s[72:75], s51 offen nt
    s_branch L_headabs_2
L_eh_11:
    v_lshrrev_b32 v48, 3, v0
    v_and_b32 v49, 7, v0
    s_lshl_b32 s52, s3, 7
    v_lshlrev_b32 v50, 10, v48
    v_add_u32 v50, s52, v50
    v_lshrrev_b32 v52, 4, v0
    v_add_u32 v51, 0, v52
    v_xor_b32 v51, v51, v49
    v_lshl_add_u32 v240, v51, 4, v50
    v_add_u32 v51, 4, v52
    v_xor_b32 v51, v51, v49
    v_lshl_add_u32 v241, v51, 4, v50
    s_lshr_b32 s63, s2, 5
    s_and_b32 s64, s2, 31
    s_lshl_b32 s60, s3, 13
    s_mul_i32 s62, s63, 4194304
    s_lshl_b32 s52, s64, 16
    s_add_u32 s62, s62, s52
    s_lshl_b32 s52, s63, 23
    s_waitcnt lgkmcnt(0)
    s_add_u32 s54, s16, s52
    s_addc_u32 s55, s17, 0
    s_mov_b32 s76, s54
    s_and_b32 s77, s55, 0xffff
    s_mov_b32 s78, 8388608
    s_mov_b32 s79, 0x20000
    s_and_b32 s62, s62, 0x7fffff
    s_add_u32 m0, s60, 0
    s_add_u32 s51, s62, 0
    buffer_load_dwordx4 v240, s[76:79], s51 offen nt lds
    s_add_u32 m0, s60, 1024
    s_add_u32 s51, s62, 8192
    buffer_load_dwordx4 v241, s[76:79], s51 offen nt lds
    s_add_u32 m0, s60, 2048
    s_add_u32 s51, s62, 16384
    buffer_load_dwordx4 v240, s[76:79], s51 offen nt lds
    s_add_u32 m0, s60, 3072
    s_add_u32 s51, s62, 24576
    buffer_load_dwordx4 v241, s[76:79], s51 offen nt lds
    s_branch L_latent_3
L_latent_3:
    s_load_dword s34, s[32:33], 0
    s_mov_b32 s36, s32
    s_and_b32 s37, s33, 0xffff
    s_mov_b32 s38, 16777216
    s_mov_b32 s39, 0x20000
    v_lshrrev_b32 v52, 4, v0
    v_and_b32 v50, 1, v0
    v_bfe_u32 v51, v0, 1, 1
    v_bfe_u32 v53, v0, 2, 2
    v_lshl_add_u32 v51, v51, 2, v53
    v_lshl_add_u32 v50, v51, 1, v50
    v_lshlrev_b32 v50, 7, v50
    v_lshl_add_u32 v50, v51, 4, v50
    v_lshl_add_u32 v50, v52, 14, v50
    s_and_b32 s52, s3, 3
    s_lshl_b32 s52, s52, 11
    v_add_u32 v50, s52, v50
    v_xor_b32 v160, 0, v50
    v_xor_b32 v161, 16, v50
    v_xor_b32 v162, 32, v50
    v_xor_b32 v163, 48, v50
    v_xor_b32 v164, 64, v50
    v_xor_b32 v165, 80, v50
    v_xor_b32 v166, 96, v50
    v_xor_b32 v167, 112, v50
    v_bfe_u32 v50, v0, 3, 1
    v_lshlrev_b32 v50, 2, v50
    v_lshrrev_b32 v51, 5, v0
    v_lshl_add_u32 v50, v51, 1, v50
    v_bfe_u32 v51, v0, 4, 1
    v_lshlrev_b32 v51, 1, v51
    v_bfe_u32 v53, v0, 1, 1
    v_add_u32 v51, v51, v53
    v_and_b32 v53, 1, v0
    v_lshlrev_b32 v53, 3, v53
    v_bfe_u32 v54, v0, 2, 1
    v_lshl_add_u32 v53, v54, 7, v53
    s_lshl_b32 s52, s3, 13
    v_add_u32 v53, s52, v53
    v_add_u32 v57, s52, v1
    v_add_u32 v58, 0x10000, v57
    v_add_u32 v54, 0, v50
    v_xor_b32 v55, v54, v51
    v_lshl_add_u32 v55, v55, 4, v53
    v_lshl_add_u32 v55, v54, 8, v55
    v_xor_b32 v168, 0, v55
    v_xor_b32 v170, 64, v55
    v_add_u32 v54, 1, v50
    v_xor_b32 v55, v54, v51
    v_lshl_add_u32 v55, v55, 4, v53
    v_lshl_add_u32 v55, v54, 8, v55
    v_xor_b32 v169, 0, v55
    v_xor_b32 v171, 64, v55
    s_lshr_b32 s52, s3, 2
    s_lshl_b32 s52, s52, 4
    v_and_b32 v49, 15, v0
    v_add_u32 v50, s52, v49
    v_mul_u32_u24 v2, 144, v50
    v_lshl_add_u32 v2, v52, 3, v2
    s_and_b32 s54, s3, 3
    s_lshl_b32 s55, s54, 5
    s_add_u32 s55, s55, 131072
    v_add_u32 v2, s55, v2
    v_and_b32 v51, 31, v0
    v_mul_u32_u24 v3, 144, v51
    v_lshrrev_b32 v53, 5, v0
    v_lshl_add_u32 v3, v53, 4, v3
    v_add_u32 v3, 131072, v3
    v_lshlrev_b32 v5, 2, v50
    v_add_u32 v5, 135680, v5
    s_lshl_b32 s55, s54, 7
    v_add_u32 v4, s55, v5
    v_lshlrev_b32 v6, 2, v51
    v_add_u32 v6, 135680, v6
    v_mov_b32 v7, 4286578688
    v_mov_b32 v8, 4286578688
    v_mov_b32 v9, 0
    v_lshlrev_b32 v28, 7, v0
    v_add_u32 v28, 135168, v28
    s_mov_b32 s58, 1069066811
    s_lshl_b32 s65, s63, 15
    s_lshl_b32 s54, s3, 12
    s_add_u32 s65, s65, s54
    s_add_u32 s65, s65, 69632
    s_add_u32 s54, s54, 131072
    v_add_u32 v30, s54, v1
    s_lshr_b32 s54, s3, 2
    s_lshl_b32 s54, s54, 14
    s_add_u32 s54, s54, 131072
    v_add_u32 v31, s54, v1
    v_mov_b32 v128, 0
    v_mov_b32 v129, 0
    v_mov_b32 v130, 0
    v_mov_b32 v131, 0
    v_mov_b32 v132, 0
    v_mov_b32 v133, 0
    v_mov_b32 v134, 0
    v_mov_b32 v135, 0
    v_mov_b32 v136, 0
    v_mov_b32 v137, 0
    v_mov_b32 v138, 0
    v_mov_b32 v139, 0
    v_mov_b32 v140, 0
    v_mov_b32 v141, 0
    v_mov_b32 v142, 0
    v_mov_b32 v143, 0
    v_mov_b32 v144, 0
    v_mov_b32 v145, 0
    v_mov_b32 v146, 0
    v_mov_b32 v147, 0
    v_mov_b32 v148, 0
    v_mov_b32 v149, 0
    v_mov_b32 v150, 0
    v_mov_b32 v151, 0
    v_mov_b32 v152, 0
    v_mov_b32 v153, 0
    v_mov_b32 v154, 0
    v_mov_b32 v155, 0
    v_mov_b32 v156, 0
    v_mov_b32 v157, 0
    v_mov_b32 v158, 0
    v_mov_b32 v159, 0
    s_mov_b32 s44, s22
    s_and_b32 s45, s23, 0xffff
    s_mov_b32 s46, 4194304
    s_mov_b32 s47, 0x20000
    s_and_b32 s52, s2, 1
    s_lshl_b32 s52, s52, 3
    s_add_u32 s52, s52, s3
    s_lshl_b32 s52, s52, 18
    s_lshr_b32 s54, s2, 1
    s_lshl_b32 s54, s54, 8
    s_add_u32 s52, s52, s54
    v_lshlrev_b32 v59, 16, v52
    v_lshl_add_u32 v59, v49, 4, v59
    v_add_u32 v59, s52, v59
    s_waitcnt lgkmcnt(0)
    s_mul_i32 s35, s34, 1664525
    s_add_u32 s35, s35, 1013904223
    s_waitcnt vmcnt(3)
    s_add_u32 m0, s60, 4096
    s_add_u32 s51, s62, 32768
    buffer_load_dwordx4 v240, s[76:79], s51 offen nt lds
    s_waitcnt vmcnt(3)
    s_add_u32 m0, s60, 5120
    s_add_u32 s51, s62, 40960
    buffer_load_dwordx4 v241, s[76:79], s51 offen nt lds
    s_waitcnt vmcnt(3)
    s_add_u32 m0, s60, 6144
    s_add_u32 s51, s62, 49152
    buffer_load_dwordx4 v240, s[76:79], s51 offen nt lds
    s_waitcnt vmcnt(3)
    s_add_u32 m0, s60, 7168
    s_add_u32 s51, s62, 57344
    buffer_load_dwordx4 v241, s[76:79], s51 offen nt lds
    s_add_u32 s62, s62, 0x200000
    s_xor_b32 s60, s60, 0x10000
    s_waitcnt vmcnt(3)
    s_and_b32 s62, s62, 0x7fffff
    s_add_u32 m0, s60, 0
    s_add_u32 s51, s62, 0
    buffer_load_dwordx4 v240, s[76:79], s51 offen nt lds
    s_waitcnt vmcnt(3)
    s_add_u32 m0, s60, 1024
    s_add_u32 s51, s62, 8192
    buffer_load_dwordx4 v241, s[76:79], s51 offen nt lds
    s_waitcnt vmcnt(3)
    s_add_u32 m0, s60, 2048
    s_add_u32 s51, s62, 16384
    buffer_load_dwordx4 v240, s[76:79], s51 offen nt lds
    s_waitcnt vmcnt(3)
    s_add_u32 m0, s60, 3072
    s_add_u32 s51, s62, 24576
    buffer_load_dwordx4 v241, s[76:79], s51 offen nt lds
    s_waitcnt vmcnt(3)
    s_add_u32 m0, s60, 4096
    s_add_u32 s51, s62, 32768
    buffer_load_dwordx4 v240, s[76:79], s51 offen nt lds
    s_waitcnt vmcnt(3)
    s_add_u32 m0, s60, 5120
    s_add_u32 s51, s62, 40960
    buffer_load_dwordx4 v241, s[76:79], s51 offen nt lds
    s_waitcnt vmcnt(3)
    s_add_u32 m0, s60, 6144
    s_add_u32 s51, s62, 49152
    buffer_load_dwordx4 v240, s[76:79], s51 offen nt lds
    s_waitcnt vmcnt(3)
    s_add_u32 m0, s60, 7168
    s_add_u32 s51, s62, 57344
    buffer_load_dwordx4 v241, s[76:79], s51 offen nt lds
    s_add_u32 s62, s62, 0x200000
    s_xor_b32 s60, s60, 0x10000
    s_waitcnt vmcnt(3)
    s_and_b32 s62, s62, 0x7fffff
    s_add_u32 s51, s62, 0
    buffer_load_dwordx4 v[12:15], v240, s[76:79], s51 offen nt
    s_waitcnt vmcnt(3)
    s_add_u32 s51, s62, 8192
    buffer_load_dwordx4 v[16:19], v241, s[76:79], s51 offen nt
    s_waitcnt vmcnt(3)
    s_add_u32 s51, s62, 16384
    buffer_load_dwordx4 v[20:23], v240, s[76:79], s51 offen nt
    s_waitcnt vmcnt(3)
    s_add_u32 s51, s62, 24576
    buffer_load_dwordx4 v[24:27], v241, s[76:79], s51 offen nt
    s_waitcnt vmcnt(3)
    s_add_u32 s51, s62, 32768
    buffer_load_dwordx4 v[172:175], v240, s[76:79], s51 offen nt
    s_waitcnt vmcnt(3)
    s_add_u32 s51, s62, 40960
    buffer_load_dwordx4 v[244:247], v241, s[76:79], s51 offen nt
    s_waitcnt vmcnt(3)
    s_add_u32 s51, s62, 49152
    buffer_load_dwordx4 v[248:251], v240, s[76:79], s51 offen nt
    s_waitcnt vmcnt(3)
    s_add_u32 s51, s62, 57344
    buffer_load_dwordx4 v[252:255], v241, s[76:79], s51 offen nt
    s_add_u32 s62, s62, 0x200000
    s_waitcnt vmcnt(3)
    s_and_b32 s62, s62, 0x7fffff
    s_add_u32 s51, s62, 0
    buffer_load_dwordx4 v[208:211], v240, s[76:79], s51 offen nt
    s_waitcnt vmcnt(3)
    s_add_u32 s51, s62, 8192
    buffer_load_dwordx4 v[212:215], v241, s[76:79], s51 offen nt
    s_waitcnt vmcnt(3)
    s_add_u32 s51, s62, 16384
    buffer_load_dwordx4 v[216:219], v240, s[76:79], s51 offen nt
    s_waitcnt vmcnt(3)
    s_add_u32 s51, s62, 24576
    buffer_load_dwordx4 v[220:223], v241, s[76:79], s51 offen nt
    s_waitcnt vmcnt(3)
    s_add_u32 s51, s62, 32768
    buffer_load_dwordx4 v[224:227], v240, s[76:79], s51 offen nt
    s_waitcnt vmcnt(3)
    s_add_u32 s51, s62, 40960
    buffer_load_dwordx4 v[228:231], v241, s[76:79], s51 offen nt
    s_waitcnt vmcnt(3)
    s_add_u32 s51, s62, 49152
    buffer_load_dwordx4 v[232:235], v240, s[76:79], s51 offen nt
    s_waitcnt vmcnt(3)
    s_add_u32 s51, s62, 57344
    buffer_load_dwordx4 v[236:239], v241, s[76:79], s51 offen nt
    s_add_u32 s62, s62, 0x200000
    s_cmp_lg_u32 s3, 0
    s_cbranch_scc1 L_pskip_13
    s_mov_b32 s53, 300000
L_poll_14:
    buffer_load_dword v61, v28, s[36:39], 0 offen sc1
    s_waitcnt vmcnt(0)
    v_cmp_ne_u32 vcc, s35, v61
    s_cbranch_vccz L_pskip_13
    s_sleep 2
    s_sub_u32 s53, s53, 1
    s_cbranch_scc0 L_poll_14
    v_mov_b32 v62, 3
    v_mov_b32 v63, 0
    global_store_dword v63, v62, s[30:31] offset:64
L_pskip_13:
    s_barrier
    buffer_load_dwordx4 v[176:179], v1, s[36:39], s65 offen offset:0 sc1
    buffer_load_dwordx4 v[180:183], v1, s[36:39], s65 offen offset:1024 sc1
    buffer_load_dwordx4 v[184:187], v1, s[36:39], s65 offen offset:2048 sc1
    buffer_load_dwordx4 v[188:191], v1, s[36:39], s65 offen offset:3072 sc1
    s_waitcnt vmcnt(3)
    ds_write_b128 v30, v[176:179] offset:0
    s_waitcnt vmcnt(2)
    ds_write_b128 v30, v[180:183] offset:1024
    s_waitcnt vmcnt(1)
    ds_write_b128 v30, v[184:187] offset:2048
    s_waitcnt vmcnt(0)
    ds_write_b128 v30, v[188:191] offset:3072
    s_waitcnt lgkmcnt(0)
    s_barrier
    ds_read_b128 v[64:67], v31 offset:0
    ds_read_b128 v[68:71], v31 offset:1024
    ds_read_b128 v[72:75], v31 offset:2048
    ds_read_b128 v[76:79], v31 offset:3072
    ds_read_b128 v[80:83], v31 offset:4096
    ds_read_b128 v[84:87], v31 offset:5120
    ds_read_b128 v[88:91], v31 offset:6144
    ds_read_b128 v[92:95], v31 offset:7168
    ds_read_b128 v[96:99], v31 offset:8192
    ds_read_b128 v[100:103], v31 offset:9216
    ds_read_b128 v[104:107], v31 offset:10240
    ds_read_b128 v[108:111], v31 offset:11264
    s_waitcnt lgkmcnt(0)
    ds_read_b128 v[112:115], v31 offset:12288
    ds_read_b128 v[116:119], v31 offset:13312
    ds_read_b128 v[120:123], v31 offset:14336
    ds_read_b128 v[124:127], v31 offset:15360
    s_waitcnt lgkmcnt(0)
    s_mov_b32 s61, 0
L_btile_15:
    s_barrier
    v_mov_b32 v32, 0
    v_mov_b32 v33, 0
    v_mov_b32 v34, 0
    v_mov_b32 v35, 0
    ds_read_b128 v[176:179], v160
    ds_read_b128 v[180:183], v161
    ds_read_b128 v[184:187], v162
    ds_read_b128 v[188:191], v163
    ds_read_b128 v[192:195], v164
    ds_read_b128 v[196:199], v165
    ds_read_b128 v[200:203], v166
    ds_read_b128 v[204:207], v167
    s_waitcnt lgkmcnt(7)
    v_mfma_f32_16x16x32_bf16 v[32:35], v[176:179], v[64:67], v[32:35]
    ds_read_b128 v[176:179], v160 offset:8192
    s_waitcnt lgkmcnt(7)
    v_mfma_f32_16x16x32_bf16 v[32:35], v[180:183], v[68:71], v[32:35]
    ds_read_b128 v[180:183], v161 offset:8192
    s_waitcnt lgkmcnt(7)
    v_mfma_f32_16x16x32_bf16 v[32:35], v[184:187], v[72:75], v[32:35]
    ds_read_b128 v[184:187], v162 offset:8192
    s_waitcnt lgkmcnt(7)
    v_mfma_f32_16x16x32_bf16 v[32:35], v[188:191], v[76:79], v[32:35]
    ds_read_b128 v[188:191], v163 offset:8192
    s_waitcnt lgkmcnt(7)
    v_mfma_f32_16x16x32_bf16 v[32:35], v[192:195], v[80:83], v[32:35]
    ds_read_b128 v[192:195], v164 offset:8192
    s_waitcnt lgkmcnt(7)
    v_mfma_f32_16x16x32_bf16 v[32:35], v[196:199], v[84:87], v[32:35]
    ds_read_b128 v[196:199], v165 offset:8192
    s_waitcnt lgkmcnt(7)
    v_mfma_f32_16x16x32_bf16 v[32:35], v[200:203], v[88:91], v[32:35]
    ds_read_b128 v[200:203], v166 offset:8192
    s_waitcnt lgkmcnt(7)
    v_mfma_f32_16x16x32_bf16 v[32:35], v[204:207], v[92:95], v[32:35]
    ds_read_b128 v[204:207], v167 offset:8192
    s_waitcnt lgkmcnt(7)
    v_mfma_f32_16x16x32_bf16 v[32:35], v[176:179], v[96:99], v[32:35]
    s_waitcnt lgkmcnt(6)
    v_mfma_f32_16x16x32_bf16 v[32:35], v[180:183], v[100:103], v[32:35]
    s_waitcnt lgkmcnt(5)
    v_mfma_f32_16x16x32_bf16 v[32:35], v[184:187], v[104:107], v[32:35]
    s_waitcnt lgkmcnt(4)
    v_mfma_f32_16x16x32_bf16 v[32:35], v[188:191], v[108:111], v[32:35]
    s_waitcnt lgkmcnt(3)
    v_mfma_f32_16x16x32_bf16 v[32:35], v[192:195], v[112:115], v[32:35]
    s_waitcnt lgkmcnt(2)
    v_mfma_f32_16x16x32_bf16 v[32:35], v[196:199], v[116:119], v[32:35]
    s_waitcnt lgkmcnt(1)
    v_mfma_f32_16x16x32_bf16 v[32:35], v[200:203], v[120:123], v[32:35]
    s_waitcnt lgkmcnt(0)
    v_mfma_f32_16x16x32_bf16 v[32:35], v[204:207], v[124:127], v[32:35]
    v_xor_b32 v160, 0x10000, v160
    v_xor_b32 v161, 0x10000, v161
    v_xor_b32 v162, 0x10000, v162
    v_xor_b32 v163, 0x10000, v163
    v_xor_b32 v164, 0x10000, v164
    v_xor_b32 v165, 0x10000, v165
    v_xor_b32 v166, 0x10000, v166
    v_xor_b32 v167, 0x10000, v167
    v_cvt_pk_bf16_f32 v36, v32, v33
    v_cvt_pk_bf16_f32 v38, v34, v35
    v_and_b32 v37, 0xffff0000, v36
    v_lshlrev_b32 v36, 16, v36
    v_and_b32 v39, 0xffff0000, v38
    v_lshlrev_b32 v38, 16, v38
    v_mul_f32 v36, 1035273459, v36
    v_mul_f32 v37, 1035273459, v37
    v_mul_f32 v38, 1035273459, v38
    v_mul_f32 v39, 1035273459, v39
    v_cvt_pk_bf16_f32 v36, v36, v37
    v_cvt_pk_bf16_f32 v38, v38, v39
    v_lshlrev_b32 v32, 16, v36
    v_and_b32 v33, 0xffff0000, v36
    v_lshlrev_b32 v34, 16, v38
    v_and_b32 v35, 0xffff0000, v38
    v_max3_f32 v36, v32, v33, v34
    v_max_f32 v36, v36, v35
    v_mov_b32 v37, v36
    s_nop 1
    v_permlane16_swap_b32 v36, v37
    v_max_f32 v36, v36, v37
    v_mov_b32 v37, v36
    s_nop 1
    v_permlane32_swap_b32 v36, v37
    v_max_f32 v36, v36, v37
    ds_write_b32 v4, v36
    s_waitcnt lgkmcnt(0)
    s_barrier
    ds_read2_b32 v[36:37], v5 offset1:32
    ds_read2_b32 v[38:39], v5 offset0:64 offset1:96
    ds_read2_b32 v[40:41], v6 offset1:32
    ds_read2_b32 v[42:43], v6 offset0:64 offset1:96
    s_waitcnt lgkmcnt(0)
    v_max3_f32 v36, v36, v37, v7
    v_max3_f32 v40, v40, v41, v8
    v_max3_f32 v36, v36, v38, v39
    v_max3_f32 v38, v40, v42, v43
    v_sub_f32 v40, v7, v36
    v_sub_f32 v41, v8, v38
    v_mul_f32 v37, s58, v36
    v_mul_f32 v40, s58, v40
    v_mul_f32 v42, s58, v41
    v_fma_f32 v32, v32, s58, -v37
    v_fma_f32 v33, v33, s58, -v37
    v_fma_f32 v34, v34, s58, -v37
    v_fma_f32 v35, v35, s58, -v37
    v_exp_f32 v40, v40
    v_exp_f32 v42, v42
    v_exp_f32 v32, v32
    v_exp_f32 v33, v33
    v_exp_f32 v34, v34
    v_exp_f32 v35, v35
    v_mov_b32 v7, v36
    v_mov_b32 v8, v38
    v_cvt_pk_bf16_f32 v44, v32, v33
    v_cvt_pk_bf16_f32 v45, v34, v35
    ds_write_b64 v2, v[44:45]
    v_fma_f32 v9, v9, v40, v32
    v_add_f32 v33, v33, v34
    v_add_f32 v9, v9, v35
    v_add_f32 v9, v9, v33
    v_mov_b32 v43, v42
    v_pk_mul_f32 v[128:129], v[128:129], v[42:43]
    v_pk_mul_f32 v[130:131], v[130:131], v[42:43]
    v_pk_mul_f32 v[132:133], v[132:133], v[42:43]
    v_pk_mul_f32 v[134:135], v[134:135], v[42:43]
    v_pk_mul_f32 v[136:137], v[136:137], v[42:43]
    v_pk_mul_f32 v[138:139], v[138:139], v[42:43]
    v_pk_mul_f32 v[140:141], v[140:141], v[42:43]
    v_pk_mul_f32 v[142:143], v[142:143], v[42:43]
    v_pk_mul_f32 v[144:145], v[144:145], v[42:43]
    v_pk_mul_f32 v[146:147], v[146:147], v[42:43]
    v_pk_mul_f32 v[148:149], v[148:149], v[42:43]
    v_pk_mul_f32 v[150:151], v[150:151], v[42:43]
    v_pk_mul_f32 v[152:153], v[152:153], v[42:43]
    v_pk_mul_f32 v[154:155], v[154:155], v[42:43]
    v_pk_mul_f32 v[156:157], v[156:157], v[42:43]
    v_pk_mul_f32 v[158:159], v[158:159], v[42:43]
    s_waitcnt lgkmcnt(0)
    s_barrier
    ds_read_b128 v[32:35], v3 offset:0
    ds_read_b128 v[36:39], v3 offset:32
    ds_read_b128 v[40:43], v3 offset:64
    ds_read_b128 v[44:47], v3 offset:96
    ds_read_b64_tr_b16 v[176:177], v168 offset:0
    ds_read_b64_tr_b16 v[178:179], v169 offset:0
    ds_read_b64_tr_b16 v[180:181], v170 offset:0
    ds_read_b64_tr_b16 v[182:183], v171 offset:0
    ds_read_b64_tr_b16 v[184:185], v168 offset:2048
    ds_read_b64_tr_b16 v[186:187], v169 offset:2048
    ds_read_b64_tr_b16 v[188:189], v170 offset:2048
    ds_read_b64_tr_b16 v[190:191], v171 offset:2048
    ds_read_b64_tr_b16 v[192:193], v168 offset:4096
    ds_read_b64_tr_b16 v[194:195], v169 offset:4096
    s_waitcnt lgkmcnt(8)
    v_mfma_f32_32x32x16_bf16 v[128:143], v[176:179], v[32:35], v[128:143]
    ds_read_b64_tr_b16 v[196:197], v170 offset:4096
    ds_read_b64_tr_b16 v[198:199], v171 offset:4096
    s_waitcnt lgkmcnt(8)
    v_mfma_f32_32x32x16_bf16 v[144:159], v[180:183], v[32:35], v[144:159]
    ds_read_b64_tr_b16 v[200:201], v168 offset:6144
    ds_read_b64_tr_b16 v[202:203], v169 offset:6144
    s_waitcnt lgkmcnt(8)
    v_mfma_f32_32x32x16_bf16 v[128:143], v[184:187], v[36:39], v[128:143]
    ds_read_b64_tr_b16 v[204:205], v170 offset:6144
    ds_read_b64_tr_b16 v[206:207], v171 offset:6144
    s_waitcnt lgkmcnt(8)
    v_mfma_f32_32x32x16_bf16 v[144:159], v[188:191], v[36:39], v[144:159]
    s_waitcnt lgkmcnt(6)
    v_mfma_f32_32x32x16_bf16 v[128:143], v[192:195], v[40:43], v[128:143]
    s_waitcnt lgkmcnt(4)
    v_mfma_f32_32x32x16_bf16 v[144:159], v[196:199], v[40:43], v[144:159]
    s_waitcnt lgkmcnt(2)
    v_mfma_f32_32x32x16_bf16 v[128:143], v[200:203], v[44:47], v[128:143]
    s_waitcnt lgkmcnt(0)
    v_mfma_f32_32x32x16_bf16 v[144:159], v[204:207], v[44:47], v[144:159]
    v_xor_b32 v168, 0x10000, v168
    v_xor_b32 v169, 0x10000, v169
    v_xor_b32 v170, 0x10000, v170
    v_xor_b32 v171, 0x10000, v171
    s_cmp_lg_u32 s61, 0
    s_cbranch_scc1 L_rf_16
    ds_write_b128 v57, v[12:15] offset:0
    ds_write_b128 v57, v[16:19] offset:1024
    ds_write_b128 v57, v[20:23] offset:2048
    ds_write_b128 v57, v[24:27] offset:3072
    ds_write_b128 v57, v[172:175] offset:4096
    ds_write_b128 v57, v[244:247] offset:5120
    ds_write_b128 v57, v[248:251] offset:6144
    ds_write_b128 v57, v[252:255] offset:7168
L_rf_16:
    s_cmp_lg_u32 s61, 1
    s_cbranch_scc1 L_rf_17
    ds_write_b128 v58, v[208:211] offset:0
    ds_write_b128 v58, v[212:215] offset:1024
    ds_write_b128 v58, v[216:219] offset:2048
    ds_write_b128 v58, v[220:223] offset:3072
    ds_write_b128 v58, v[224:227] offset:4096
    ds_write_b128 v58, v[228:231] offset:5120
    ds_write_b128 v58, v[232:235] offset:6144
    ds_write_b128 v58, v[236:239] offset:7168
    s_waitcnt lgkmcnt(0)
    s_mov_b32 s51, 0
    buffer_load_dwordx4 v[208:211], v59, s[44:47], s51 offen nt
    s_mov_b32 s51, 8192
    buffer_load_dwordx4 v[212:215], v59, s[44:47], s51 offen nt
    s_mov_b32 s51, 16384
    buffer_load_dwordx4 v[216:219], v59, s[44:47], s51 offen nt
    s_mov_b32 s51, 24576
    buffer_load_dwordx4 v[220:223], v59, s[44:47], s51 offen nt
    s_mov_b32 s51, 32768
    buffer_load_dwordx4 v[224:227], v59, s[44:47], s51 offen nt
    s_mov_b32 s51, 40960
    buffer_load_dwordx4 v[228:231], v59, s[44:47], s51 offen nt
    s_mov_b32 s51, 49152
    buffer_load_dwordx4 v[232:235], v59, s[44:47], s51 offen nt
    s_mov_b32 s51, 57344
    buffer_load_dwordx4 v[236:239], v59, s[44:47], s51 offen nt
L_rf_17:
    s_waitcnt lgkmcnt(0)
    s_add_u32 s61, s61, 1
    s_cmp_lg_u32 s61, 4
    s_cbranch_scc1 L_btile_15
    v_mov_b32 v37, v9
    s_nop 1
    v_permlane16_swap_b32 v9, v37
    v_add_f32 v9, v9, v37
    v_mov_b32 v37, v9
    s_nop 1
    v_permlane32_swap_b32 v9, v37
    v_add_f32 v9, v9, v37
    ds_write_b32 v4, v9 offset:512
    s_waitcnt lgkmcnt(0)
    s_barrier
    ds_read2_b32 v[36:37], v6 offset0:128 offset1:160
    ds_read2_b32 v[38:39], v6 offset0:192 offset1:224
    v_and_b32 v48, 31, v0
    v_mul_u32_u24 v48, 144, v48
    v_lshrrev_b32 v49, 5, v0
    v_lshl_add_u32 v48, v49, 3, v48
    s_lshl_b32 s54, s3, 13
    v_add_u32 v48, s54, v48
    v_lshrrev_b32 v49, 3, v0
    v_mul_u32_u24 v50, 144, v49
    v_and_b32 v51, 7, v0
    v_lshl_add_u32 v50, v51, 4, v50
    v_add_u32 v50, s54, v50
    v_lshlrev_b32 v52, 10, v49
    v_lshl_add_u32 v52, v51, 4, v52
    s_mul_i32 s52, s2, 32768
    s_lshl_b32 s54, s3, 7
    s_add_u32 s52, s52, s54
    s_add_u32 s52, s52, 2097152
    s_waitcnt lgkmcnt(0)
    v_add_f32 v36, v36, v37
    v_add_f32 v38, v38, v39
    v_add_f32 v36, v36, v38
    v_rcp_f32 v38, v36
    v_log_f32 v40, v36
    v_mov_b32 v39, v38
    v_fma_f32 v40, v8, s58, v40
    v_pk_mul_f32 v[128:129], v[128:129], v[38:39]
    v_pk_mul_f32 v[130:131], v[130:131], v[38:39]
    v_cvt_pk_bf16_f32 v128, v128, v129
    v_cvt_pk_bf16_f32 v129, v130, v131
    ds_write_b64 v48, v[128:129] offset:0
    v_pk_mul_f32 v[132:133], v[132:133], v[38:39]
    v_pk_mul_f32 v[134:135], v[134:135], v[38:39]
    v_cvt_pk_bf16_f32 v132, v132, v133
    v_cvt_pk_bf16_f32 v133, v134, v135
    ds_write_b64 v48, v[132:133] offset:16
    v_pk_mul_f32 v[136:137], v[136:137], v[38:39]
    v_pk_mul_f32 v[138:139], v[138:139], v[38:39]
    v_cvt_pk_bf16_f32 v136, v136, v137
    v_cvt_pk_bf16_f32 v137, v138, v139
    ds_write_b64 v48, v[136:137] offset:32
    v_pk_mul_f32 v[140:141], v[140:141], v[38:39]
    v_pk_mul_f32 v[142:143], v[142:143], v[38:39]
    v_cvt_pk_bf16_f32 v140, v140, v141
    v_cvt_pk_bf16_f32 v141, v142, v143
    ds_write_b64 v48, v[140:141] offset:48
    v_pk_mul_f32 v[144:145], v[144:145], v[38:39]
    v_pk_mul_f32 v[146:147], v[146:147], v[38:39]
    v_cvt_pk_bf16_f32 v144, v144, v145
    v_cvt_pk_bf16_f32 v145, v146, v147
    ds_write_b64 v48, v[144:145] offset:64
    v_pk_mul_f32 v[148:149], v[148:149], v[38:39]
    v_pk_mul_f32 v[150:151], v[150:151], v[38:39]
    v_cvt_pk_bf16_f32 v148, v148, v149
    v_cvt_pk_bf16_f32 v149, v150, v151
    ds_write_b64 v48, v[148:149] offset:80
    v_pk_mul_f32 v[152:153], v[152:153], v[38:39]
    v_pk_mul_f32 v[154:155], v[154:155], v[38:39]
    v_cvt_pk_bf16_f32 v152, v152, v153
    v_cvt_pk_bf16_f32 v153, v154, v155
    ds_write_b64 v48, v[152:153] offset:96
    v_pk_mul_f32 v[156:157], v[156:157], v[38:39]
    v_pk_mul_f32 v[158:159], v[158:159], v[38:39]
    v_cvt_pk_bf16_f32 v156, v156, v157
    v_cvt_pk_bf16_f32 v157, v158, v159
    ds_write_b64 v48, v[156:157] offset:112
    s_waitcnt lgkmcnt(0)
    ds_read_b128 v[176:179], v50 offset:0
    ds_read_b128 v[180:183], v50 offset:1152
    ds_read_b128 v[184:187], v50 offset:2304
    ds_read_b128 v[188:191], v50 offset:3456
    s_waitcnt lgkmcnt(3)
    buffer_store_dwordx4 v[176:179], v52, s[36:39], s52 offen sc1
    s_add_u32 s52, s52, 8192
    s_waitcnt lgkmcnt(2)
    buffer_store_dwordx4 v[180:183], v52, s[36:39], s52 offen sc1
    s_add_u32 s52, s52, 8192
    s_waitcnt lgkmcnt(1)
    buffer_store_dwordx4 v[184:187], v52, s[36:39], s52 offen sc1
    s_add_u32 s52, s52, 8192
    s_waitcnt lgkmcnt(0)
    buffer_store_dwordx4 v[188:191], v52, s[36:39], s52 offen sc1
    s_add_u32 s52, s52, 8192
    s_cmp_lg_u32 s3, 0
    s_cbranch_scc1 L_nopbs_18
    s_lshl_b32 s52, s2, 7
    s_add_u32 s52, s52, 151552
    v_lshlrev_b32 v48, 2, v0
    s_mov_b32 exec_hi, 0
    buffer_store_dword v40, v48, s[36:39], s52 offen sc1
    s_mov_b64 exec, -1
L_nopbs_18:
    s_waitcnt vmcnt(0)
    s_barrier
    s_cmp_lg_u32 s3, 0
    s_cbranch_scc1 L_nofb_19
    s_lshl_b32 s52, s2, 7
    s_add_u32 s52, s52, 143360
    v_mov_b32 v50, s35
    v_mov_b32 v51, 0
    s_mov_b64 exec, 1
    buffer_store_dword v50, v51, s[36:39], s52 offen sc1
    s_mov_b64 exec, -1
L_nofb_19:
    v_and_b32 v48, 1, v0
    v_mov_b32 v49, 0x0c0c0100
    v_mov_b32 v50, 0x01000c0c
    v_mov_b32 v51, 0x0c0c0302
    v_mov_b32 v52, 0x03020c0c
    v_mov_b32 v53, 0x0c0c0c0c
    v_cmp_eq_u32 vcc, 1, v48
    v_bfe_u32 v54, v0, 1, 2
    s_nop 0
    v_cndmask_b32 v49, v49, v50, vcc
    v_cndmask_b32 v51, v51, v52, vcc
    v_cmp_eq_u32 vcc, 0, v54
    s_nop 1
    v_cndmask_b32 v2, v53, v49, vcc
    v_cndmask_b32 v6, v53, v51, vcc
    v_cmp_eq_u32 vcc, 1, v54
    s_nop 1
    v_cndmask_b32 v3, v53, v49, vcc
    v_cndmask_b32 v7, v53, v51, vcc
    v_cmp_eq_u32 vcc, 2, v54
    s_nop 1
    v_cndmask_b32 v4, v53, v49, vcc
    v_cndmask_b32 v8, v53, v51, vcc
    v_cmp_eq_u32 vcc, 3, v54
    s_nop 1
    v_cndmask_b32 v5, v53, v49, vcc
    v_cndmask_b32 v9, v53, v51, vcc
    v_lshlrev_b32 v28, 7, v0
    v_add_u32 v28, 143360, v28
    v_lshrrev_b32 v48, 5, v0
    v_lshlrev_b32 v29, 7, v48
    v_mul_u32_u24 v31, 32768, v48
    v_and_b32 v49, 31, v0
    v_lshl_add_u32 v31, v49, 4, v31
    s_lshr_b32 s54, s2, 1
    s_lshl_b32 s55, s54, 2
    s_lshl_b32 s52, s3, 10
    s_add_u32 s55, s55, s52
    s_add_u32 s55, s55, 151552
    v_add_u32 v25, s52, v1
    s_lshl_b32 s56, s2, 9
    s_mul_i32 s52, s3, 262144
    s_add_u32 s56, s56, s52
    s_add_u32 s56, s56, 2097152
    s_lshl_b32 s52, s3, 1
    v_add_u32 v50, s52, v48
    v_mul_u32_u24 v26, 1040, v50
    v_lshl_add_u32 v26, v49, 5, v26
    v_add_u32 v26, 16384, v26
    v_and_b32 v50, 15, v0
    v_mul_u32_u24 v27, 1040, v50
    v_lshrrev_b32 v51, 4, v0
    v_lshl_add_u32 v27, v51, 5, v27
    s_lshl_b32 s52, s3, 7
    s_add_u32 s52, s52, 16384
    v_add_u32 v27, s52, v27
    v_lshrrev_b32 v50, 1, v50
    v_lshlrev_b32 v24, 3, v50
    v_add_u32 v24, 33024, v24
    s_lshl_b32 s52, s3, 3
    s_add_u32 s52, s52, 33024
    v_mov_b32 v23, s52
    v_mov_b32 v32, 0
    v_mov_b32 v33, 0
    v_mov_b32 v34, 0
    v_mov_b32 v35, 0
    v_and_b32 v30, 7, v0
    v_lshlrev_b32 v30, 4, v30
    v_bfe_u32 v48, v0, 3, 2
    v_lshl_add_u32 v30, v48, 2, v30
    v_lshrrev_b32 v48, 5, v0
    v_lshl_add_u32 v30, v48, 8, v30
    s_and_b32 s52, s3, 1
    s_lshl_b32 s52, s52, 9
    s_lshr_b32 s54, s3, 1
    s_lshl_b32 s54, s54, 7
    s_add_u32 s52, s52, s54
    s_add_u32 s52, s52, 0
    v_add_u32 v30, s52, v30
    s_lshr_b32 s52, s3, 1
    s_lshl_b32 s52, s52, 5
    s_lshr_b32 s54, s2, 1
    s_add_u32 s52, s52, s54
    s_add_u32 s52, s52, 64
    s_lshl_b32 s52, s52, 3
    s_and_b32 s54, s2, 1
    s_add_u32 s52, s52, s54
    s_lshl_b32 s52, s52, 9
    s_add_u32 s52, s52, 196608
    s_and_b32 s54, s3, 1
    s_lshl_b32 s54, s54, 8
    v_lshlrev_b32 v50, 2, v0
    v_add_u32 v50, s54, v50
    v_mov_b32 v59, s35
    v_mov_b32 v58, 0
    s_cmp_lg_u32 s3, 0
    s_cbranch_scc1 L_pskip_20
    s_mov_b32 s53, 300000
L_poll_21:
    buffer_load_dword v61, v28, s[36:39], 0 offen sc1
    s_waitcnt vmcnt(0)
    v_cmp_ne_u32 vcc, s35, v61
    s_cbranch_vccz L_pskip_20
    s_sleep 1
    s_sub_u32 s53, s53, 1
    s_cbranch_scc0 L_poll_21
    v_mov_b32 v62, 4
    v_mov_b32 v63, 0
    global_store_dword v63, v62, s[30:31] offset:64
L_pskip_20:
    s_barrier
    buffer_load_dword v36, v29, s[36:39], s55 offen offset:0 sc1
    buffer_load_dword v37, v29, s[36:39], s55 offen offset:256 sc1
    buffer_load_dword v38, v29, s[36:39], s55 offen offset:512 sc1
    buffer_load_dword v39, v29, s[36:39], s55 offen offset:768 sc1
    buffer_load_dwordx4 v[64:67], v31, s[36:39], s56 offen sc1
    s_add_u32 s56, s56, 65536
    buffer_load_dwordx4 v[68:71], v31, s[36:39], s56 offen sc1
    s_add_u32 s56, s56, 65536
    buffer_load_dwordx4 v[72:75], v31, s[36:39], s56 offen sc1
    s_add_u32 s56, s56, 65536
    buffer_load_dwordx4 v[76:79], v31, s[36:39], s56 offen sc1
    s_add_u32 s56, s56, 65536
    s_waitcnt vmcnt(4)
    v_max3_f32 v40, v36, v37, v38
    v_max_f32 v40, v40, v39
    v_mov_b32 v41, v40
    s_nop 1
    v_permlane32_swap_b32 v40, v41
    v_max_f32 v40, v40, v41
    v_sub_f32 v36, v36, v40
    v_sub_f32 v37, v37, v40
    v_sub_f32 v38, v38, v40
    v_sub_f32 v39, v39, v40
    v_exp_f32 v36, v36
    v_exp_f32 v37, v37
    v_exp_f32 v38, v38
    v_exp_f32 v39, v39
    v_add_f32 v41, v36, v37
    v_add_f32 v42, v38, v39
    v_add_f32 v41, v41, v42
    v_mov_b32 v42, v41
    s_nop 1
    v_permlane32_swap_b32 v41, v42
    v_add_f32 v41, v41, v42
    ds_write_b64 v23, v[40:41]
    s_waitcnt vmcnt(3)
    v_lshlrev_b32 v42, 16, v64
    v_and_b32 v43, 0xffff0000, v64
    v_mul_f32 v12, v36, v42
    v_mul_f32 v13, v36, v43
    v_lshlrev_b32 v42, 16, v65
    v_and_b32 v43, 0xffff0000, v65
    v_mul_f32 v14, v36, v42
    v_mul_f32 v15, v36, v43
    v_lshlrev_b32 v42, 16, v66
    v_and_b32 v43, 0xffff0000, v66
    v_mul_f32 v16, v36, v42
    v_mul_f32 v17, v36, v43
    v_lshlrev_b32 v42, 16, v67
    v_and_b32 v43, 0xffff0000, v67
    v_mul_f32 v18, v36, v42
    v_mul_f32 v19, v36, v43
    s_waitcnt vmcnt(2)
    v_lshlrev_b32 v42, 16, v68
    v_and_b32 v43, 0xffff0000, v68
    v_fmac_f32 v12, v37, v42
    v_fmac_f32 v13, v37, v43
    v_lshlrev_b32 v42, 16, v69
    v_and_b32 v43, 0xffff0000, v69
    v_fmac_f32 v14, v37, v42
    v_fmac_f32 v15, v37, v43
    v_lshlrev_b32 v42, 16, v70
    v_and_b32 v43, 0xffff0000, v70
    v_fmac_f32 v16, v37, v42
    v_fmac_f32 v17, v37, v43
    v_lshlrev_b32 v42, 16, v71
    v_and_b32 v43, 0xffff0000, v71
    v_fmac_f32 v18, v37, v42
    v_fmac_f32 v19, v37, v43
    s_waitcnt vmcnt(1)
    v_lshlrev_b32 v42, 16, v72
    v_and_b32 v43, 0xffff0000, v72
    v_fmac_f32 v12, v38, v42
    v_fmac_f32 v13, v38, v43
    v_lshlrev_b32 v42, 16, v73
    v_and_b32 v43, 0xffff0000, v73
    v_fmac_f32 v14, v38, v42
    v_fmac_f32 v15, v38, v43
    v_lshlrev_b32 v42, 16, v74
    v_and_b32 v43, 0xffff0000, v74
    v_fmac_f32 v16, v38, v42
    v_fmac_f32 v17, v38, v43
    v_lshlrev_b32 v42, 16, v75
    v_and_b32 v43, 0xffff0000, v75
    v_fmac_f32 v18, v38, v42
    v_fmac_f32 v19, v38, v43
    s_waitcnt vmcnt(0)
    v_lshlrev_b32 v42, 16, v76
    v_and_b32 v43, 0xffff0000, v76
    v_fmac_f32 v12, v39, v42
    v_fmac_f32 v13, v39, v43
    v_lshlrev_b32 v42, 16, v77
    v_and_b32 v43, 0xffff0000, v77
    v_fmac_f32 v14, v39, v42
    v_fmac_f32 v15, v39, v43
    v_lshlrev_b32 v42, 16, v78
    v_and_b32 v43, 0xffff0000, v78
    v_fmac_f32 v16, v39, v42
    v_fmac_f32 v17, v39, v43
    v_lshlrev_b32 v42, 16, v79
    v_and_b32 v43, 0xffff0000, v79
    v_fmac_f32 v18, v39, v42
    v_fmac_f32 v19, v39, v43
    ds_write_b128 v26, v[12:15]
    ds_write_b128 v26, v[16:19] offset:16
    s_waitcnt lgkmcnt(0)
    s_barrier
    ds_read_b64 v[40:41], v24
    ds_read_b128 v[12:15], v27
    ds_read_b128 v[16:19], v27 offset:16
    s_waitcnt lgkmcnt(0)
    v_mov_b32 v42, v40
    s_nop 1
    v_max_f32_dpp v42, v42, v42 row_half_mirror row_mask:0xf bank_mask:0xf
    s_nop 1
    v_max_f32_dpp v42, v42, v42 quad_perm:[1,0,3,2] row_mask:0xf bank_mask:0xf
    s_nop 1
    v_max_f32_dpp v42, v42, v42 quad_perm:[2,3,0,1] row_mask:0xf bank_mask:0xf
    v_sub_f32 v40, v40, v42
    v_exp_f32 v40, v40
    s_nop 0
    v_mul_f32 v41, v41, v40
    s_nop 1
    v_add_f32_dpp v41, v41, v41 row_half_mirror row_mask:0xf bank_mask:0xf
    s_nop 1
    v_add_f32_dpp v41, v41, v41 quad_perm:[1,0,3,2] row_mask:0xf bank_mask:0xf
    s_nop 1
    v_add_f32_dpp v41, v41, v41 quad_perm:[2,3,0,1] row_mask:0xf bank_mask:0xf
    v_rcp_f32 v41, v41
    v_add_f32 v40, v40, v40
    v_mul_f32 v40, v40, v41
    v_mul_f32 v12, v40, v12
    v_mul_f32 v13, v40, v13
    v_mul_f32 v14, v40, v14
    v_mul_f32 v15, v40, v15
    v_mul_f32 v16, v40, v16
    v_mul_f32 v17, v40, v17
    v_mul_f32 v18, v40, v18
    v_mul_f32 v19, v40, v19
    v_add_f32_dpp v12, v12, v12 row_half_mirror row_mask:0xf bank_mask:0xf
    v_add_f32_dpp v13, v13, v13 row_half_mirror row_mask:0xf bank_mask:0xf
    v_add_f32_dpp v14, v14, v14 row_half_mirror row_mask:0xf bank_mask:0xf
    v_add_f32_dpp v15, v15, v15 row_half_mirror row_mask:0xf bank_mask:0xf
    v_add_f32_dpp v16, v16, v16 row_half_mirror row_mask:0xf bank_mask:0xf
    v_add_f32_dpp v17, v17, v17 row_half_mirror row_mask:0xf bank_mask:0xf
    v_add_f32_dpp v18, v18, v18 row_half_mirror row_mask:0xf bank_mask:0xf
    v_add_f32_dpp v19, v19, v19 row_half_mirror row_mask:0xf bank_mask:0xf
    v_add_f32_dpp v12, v12, v12 quad_perm:[1,0,3,2] row_mask:0xf bank_mask:0xf
    v_add_f32_dpp v13, v13, v13 quad_perm:[1,0,3,2] row_mask:0xf bank_mask:0xf
    v_add_f32_dpp v14, v14, v14 quad_perm:[1,0,3,2] row_mask:0xf bank_mask:0xf
    v_add_f32_dpp v15, v15, v15 quad_perm:[1,0,3,2] row_mask:0xf bank_mask:0xf
    v_add_f32_dpp v16, v16, v16 quad_perm:[1,0,3,2] row_mask:0xf bank_mask:0xf
    v_add_f32_dpp v17, v17, v17 quad_perm:[1,0,3,2] row_mask:0xf bank_mask:0xf
    v_add_f32_dpp v18, v18, v18 quad_perm:[1,0,3,2] row_mask:0xf bank_mask:0xf
    v_add_f32_dpp v19, v19, v19 quad_perm:[1,0,3,2] row_mask:0xf bank_mask:0xf
    v_add_f32_dpp v12, v12, v12 quad_perm:[2,3,0,1] row_mask:0xf bank_mask:0xf
    v_add_f32_dpp v13, v13, v13 quad_perm:[2,3,0,1] row_mask:0xf bank_mask:0xf
    v_add_f32_dpp v14, v14, v14 quad_perm:[2,3,0,1] row_mask:0xf bank_mask:0xf
    v_add_f32_dpp v15, v15, v15 quad_perm:[2,3,0,1] row_mask:0xf bank_mask:0xf
    v_add_f32_dpp v16, v16, v16 quad_perm:[2,3,0,1] row_mask:0xf bank_mask:0xf
    v_add_f32_dpp v17, v17, v17 quad_perm:[2,3,0,1] row_mask:0xf bank_mask:0xf
    v_add_f32_dpp v18, v18, v18 quad_perm:[2,3,0,1] row_mask:0xf bank_mask:0xf
    v_add_f32_dpp v19, v19, v19 quad_perm:[2,3,0,1] row_mask:0xf bank_mask:0xf
    v_cvt_pk_bf16_f32 v60, v12, v13
    v_cvt_pk_bf16_f32 v61, v14, v15
    v_cvt_pk_bf16_f32 v62, v16, v17
    v_cvt_pk_bf16_f32 v63, v18, v19
    v_perm_b32 v40, v60, v60, v2
    v_perm_b32 v41, v60, v60, v3
    v_perm_b32 v42, v60, v60, v4
    v_perm_b32 v43, v60, v60, v5
    v_perm_b32 v44, v60, v60, v6
    v_perm_b32 v45, v60, v60, v7
    v_perm_b32 v46, v60, v60, v8
    v_perm_b32 v47, v60, v60, v9
    v_mfma_f32_16x16x32_bf16 v[32:35], v[208:211], v[40:43], v[32:35]
    s_nop 0
    v_mfma_f32_16x16x32_bf16 v[32:35], v[212:215], v[44:47], v[32:35]
    v_perm_b32 v40, v61, v61, v2
    v_perm_b32 v41, v61, v61, v3
    v_perm_b32 v42, v61, v61, v4
    v_perm_b32 v43, v61, v61, v5
    v_perm_b32 v44, v61, v61, v6
    v_perm_b32 v45, v61, v61, v7
    v_perm_b32 v46, v61, v61, v8
    v_perm_b32 v47, v61, v61, v9
    v_mfma_f32_16x16x32_bf16 v[32:35], v[216:219], v[40:43], v[32:35]
    s_nop 0
    v_mfma_f32_16x16x32_bf16 v[32:35], v[220:223], v[44:47], v[32:35]
    v_perm_b32 v40, v62, v62, v2
    v_perm_b32 v41, v62, v62, v3
    v_perm_b32 v42, v62, v62, v4
    v_perm_b32 v43, v62, v62, v5
    v_perm_b32 v44, v62, v62, v6
    v_perm_b32 v45, v62, v62, v7
    v_perm_b32 v46, v62, v62, v8
    v_perm_b32 v47, v62, v62, v9
    v_mfma_f32_16x16x32_bf16 v[32:35], v[224:227], v[40:43], v[32:35]
    s_nop 0
    v_mfma_f32_16x16x32_bf16 v[32:35], v[228:231], v[44:47], v[32:35]
    v_perm_b32 v40, v63, v63, v2
    v_perm_b32 v41, v63, v63, v3
    v_perm_b32 v42, v63, v63, v4
    v_perm_b32 v43, v63, v63, v5
    v_perm_b32 v44, v63, v63, v6
    v_perm_b32 v45, v63, v63, v7
    v_perm_b32 v46, v63, v63, v8
    v_perm_b32 v47, v63, v63, v9
    v_mfma_f32_16x16x32_bf16 v[32:35], v[232:235], v[40:43], v[32:35]
    s_nop 0
    v_mfma_f32_16x16x32_bf16 v[32:35], v[236:239], v[44:47], v[32:35]
    s_nop 7
    ds_write_b128 v25, v[32:35]
    s_waitcnt lgkmcnt(0)
    s_barrier
    s_cmp_ge_u32 s3, 4
    s_cbranch_scc1 L_nostat_22
    ds_read_b32 v40, v30 offset:0
    ds_read_b32 v41, v30 offset:1024
    ds_read_b32 v42, v30 offset:2048
    ds_read_b32 v43, v30 offset:3072
    ds_read_b32 v44, v30 offset:4096
    ds_read_b32 v45, v30 offset:5120
    ds_read_b32 v46, v30 offset:6144
    ds_read_b32 v47, v30 offset:7168
    s_waitcnt lgkmcnt(0)
    v_add_f32 v40, v40, v41
    v_add_f32 v42, v42, v43
    v_add_f32 v44, v44, v45
    v_add_f32 v46, v46, v47
    v_add_f32 v40, v40, v42
    v_add_f32 v44, v44, v46
    v_add_f32 v54, v40, v44
    s_nop 1
    v_mov_b32_dpp v55, v54 quad_perm:[1,0,3,2] row_mask:0xf bank_mask:0xf
    v_cvt_pk_bf16_f32 v56, v54, v55
    s_nop 1
    v_mov_b32_dpp v57, v56 quad_perm:[2,3,0,1] row_mask:0xf bank_mask:0xf
    s_mov_b32 exec_lo, 0x11111111
    s_mov_b32 exec_hi, 0x11111111
    buffer_store_dwordx4 v[56:59], v50, s[36:39], s52 offen sc1
    s_mov_b64 exec, -1
L_nostat_22:
    s_cmp_ge_u32 s2, 36
    s_cbranch_scc1 L_fin_5
    s_cmp_ge_u32 s2, 18
    s_cselect_b32 s49, 1, 0
    s_mul_i32 s52, s49, 18
    s_sub_u32 s50, s2, s52
    s_mul_i32 s76, s49, 1152
    v_lshrrev_b32 v24, 3, v0
    v_mul_u32_u24 v163, 9216, v24
    v_and_b32 v24, 7, v0
    v_lshl_add_u32 v163, v24, 4, v163
    s_mul_i32 s52, s49, 4608
    s_lshl_b32 s54, s50, 8
    s_add_u32 s52, s52, s54
    s_mul_i32 s54, s3, 73728
    s_add_u32 s52, s52, s54
    s_add_u32 s77, s52, 1376256
    v_lshlrev_b32 v20, 2, v0
    s_lshl_b32 s52, s3, 8
    s_add_u32 s52, s52, 40960
    v_add_u32 v164, s52, v20
    s_cmp_lg_u32 s3, 0
    s_cbranch_scc1 L_nogate_23
    s_add_u32 s54, s4, s76
    s_addc_u32 s55, s5, 0
    s_mov_b32 s40, s54
    s_and_b32 s41, s55, 0xffff
    s_mov_b32 s42, 1152
    s_mov_b32 s43, 0x20000
    s_mov_b32 s44, s26
    s_and_b32 s45, s27, 0xffff
    s_mov_b32 s46, 1152
    s_mov_b32 s47, 0x20000
    buffer_load_dword v10, v20, s[40:43], 0 offen offset:0
    buffer_load_dword v15, v20, s[44:47], 0 offen offset:0
    buffer_load_dword v11, v20, s[40:43], 0 offen offset:256
    buffer_load_dword v16, v20, s[44:47], 0 offen offset:256
    buffer_load_dword v12, v20, s[40:43], 0 offen offset:512
    buffer_load_dword v17, v20, s[44:47], 0 offen offset:512
    buffer_load_dword v13, v20, s[40:43], 0 offen offset:768
    buffer_load_dword v18, v20, s[44:47], 0 offen offset:768
    buffer_load_dword v14, v20, s[40:43], 0 offen offset:1024
    buffer_load_dword v19, v20, s[44:47], 0 offen offset:1024
    v_lshlrev_b32 v162, 2, v24
    v_bfe_u32 v24, v0, 4, 1
    v_lshl_add_u32 v162, v24, 1, v162
    v_lshrrev_b32 v24, 5, v0
    v_lshl_add_u32 v162, v24, 5, v162
    s_lshl_b32 s54, s50, 6
    s_add_u32 s76, s76, s54
    v_mov_b32 v22, 0
    s_waitcnt vmcnt(0)
    v_lshlrev_b32 v24, 16, v10
    v_and_b32 v25, 0xffff0000, v10
    v_lshlrev_b32 v26, 16, v15
    v_and_b32 v27, 0xffff0000, v15
    v_mul_f32 v24, v24, v26
    v_mul_f32 v25, v25, v27
    v_cvt_pk_bf16_f32 v24, v24, v25
    v_lshlrev_b32 v25, 16, v24
    v_and_b32 v24, 0xffff0000, v24
    v_add_f32 v22, v22, v25
    v_add_f32 v22, v22, v24
    v_lshlrev_b32 v24, 16, v11
    v_and_b32 v25, 0xffff0000, v11
    v_lshlrev_b32 v26, 16, v16
    v_and_b32 v27, 0xffff0000, v16
    v_mul_f32 v24, v24, v26
    v_mul_f32 v25, v25, v27
    v_cvt_pk_bf16_f32 v24, v24, v25
    v_lshlrev_b32 v25, 16, v24
    v_and_b32 v24, 0xffff0000, v24
    v_add_f32 v22, v22, v25
    v_add_f32 v22, v22, v24
    v_lshlrev_b32 v24, 16, v12
    v_and_b32 v25, 0xffff0000, v12
    v_lshlrev_b32 v26, 16, v17
    v_and_b32 v27, 0xffff0000, v17
    v_mul_f32 v24, v24, v26
    v_mul_f32 v25, v25, v27
    v_cvt_pk_bf16_f32 v24, v24, v25
    v_lshlrev_b32 v25, 16, v24
    v_and_b32 v24, 0xffff0000, v24
    v_add_f32 v22, v22, v25
    v_add_f32 v22, v22, v24
    v_lshlrev_b32 v24, 16, v13
    v_and_b32 v25, 0xffff0000, v13
    v_lshlrev_b32 v26, 16, v18
    v_and_b32 v27, 0xffff0000, v18
    v_mul_f32 v24, v24, v26
    v_mul_f32 v25, v25, v27
    v_cvt_pk_bf16_f32 v24, v24, v25
    v_lshlrev_b32 v25, 16, v24
    v_and_b32 v24, 0xffff0000, v24
    v_add_f32 v22, v22, v25
    v_add_f32 v22, v22, v24
    v_lshlrev_b32 v24, 16, v14
    v_and_b32 v25, 0xffff0000, v14
    v_lshlrev_b32 v26, 16, v19
    v_and_b32 v27, 0xffff0000, v19
    v_mul_f32 v24, v24, v26
    v_mul_f32 v25, v25, v27
    v_cvt_pk_bf16_f32 v24, v24, v25
    v_lshlrev_b32 v25, 16, v24
    v_and_b32 v24, 0xffff0000, v24
    v_add_f32 v22, v22, v25
    v_add_f32 v22, v22, v24
    s_nop 1
    v_add_f32_dpp v22, v22, v22 row_half_mirror row_mask:0xf bank_mask:0xf
    s_nop 1
    v_add_f32_dpp v22, v22, v22 quad_perm:[1,0,3,2] row_mask:0xf bank_mask:0xf
    s_nop 1
    v_add_f32_dpp v22, v22, v22 quad_perm:[2,3,0,1] row_mask:0xf bank_mask:0xf
    s_nop 1
    v_add_f32_dpp v22, v22, v22 row_ror:8 row_mask:0xf bank_mask:0xf
    v_mov_b32 v24, v22
    s_nop 1
    v_permlane16_swap_b32 v22, v24
    v_add_f32 v22, v22, v24
    v_mov_b32 v24, v22
    s_nop 1
    v_permlane32_swap_b32 v22, v24
    v_add_f32 v22, v22, v24
    v_cvt_pk_bf16_f32 v22, v22, v22
    v_and_b32 v22, 0xffff0000, v22
    v_mul_f32 v22, 1069066811, v22
    v_exp_f32 v22, -v22
    s_nop 0
    v_add_f32 v22, 1.0, v22
    v_rcp_f32 v22, v22
    s_nop 0
    v_cvt_pk_bf16_f32 v22, v22, v22
    v_and_b32 v160, 0xffff0000, v22
    v_sub_f32 v23, 1.0, v160
    v_cvt_pk_bf16_f32 v23, v23, v23
    v_and_b32 v161, 0xffff0000, v23
L_nogate_23:
    s_mov_b32 s40, s28
    s_and_b32 s41, s29, 0xffff
    s_mov_b32 s42, 2304
    s_mov_b32 s43, 0x20000
    s_cmp_lg_u32 s3, 4
    s_cbranch_scc1 L_f8t_24
    s_mov_b32 s53, 300000
L_gpoll_25:
    buffer_load_dwordx4 v[64:67], v163, s[36:39], s77 offen sc1
    buffer_load_dwordx4 v[68:71], v163, s[36:39], s77 offen offset:128 sc1
    s_waitcnt vmcnt(0)
    v_xor_b32 v48, s35, v65
    v_bitop3_b32 v48, v48, v67, s35 bitop3:0xf6
    v_bitop3_b32 v48, v48, v69, s35 bitop3:0xf6
    v_bitop3_b32 v48, v48, v71, s35 bitop3:0xf6
    v_cmp_ne_u32 vcc, 0, v48
    s_cbranch_vccz L_gdone_26
    s_sleep 4
    s_sub_u32 s53, s53, 1
    s_cbranch_scc0 L_gpoll_25
    v_mov_b32 v62, 7
    v_mov_b32 v63, 0
    global_store_dword v63, v62, s[30:31] offset:64
    s_waitcnt vmcnt(0)
L_gdone_26:
L_f8t_24:
    s_barrier
    s_mov_b32 s53, 300000
L_gpoll_28:
    buffer_load_dwordx4 v[64:67], v163, s[36:39], s77 offen sc1
    buffer_load_dwordx4 v[68:71], v163, s[36:39], s77 offen offset:128 sc1
    s_waitcnt vmcnt(0)
    v_xor_b32 v48, s35, v65
    v_bitop3_b32 v48, v48, v67, s35 bitop3:0xf6
    v_bitop3_b32 v48, v48, v69, s35 bitop3:0xf6
    v_bitop3_b32 v48, v48, v71, s35 bitop3:0xf6
    v_cmp_ne_u32 vcc, 0, v48
    s_cbranch_vccz L_gdone_29
    s_sleep 1
    s_sub_u32 s53, s53, 1
    s_cbranch_scc0 L_gpoll_28
    v_mov_b32 v62, 8
    v_mov_b32 v63, 0
    global_store_dword v63, v62, s[30:31] offset:64
    s_waitcnt vmcnt(0)
L_gdone_29:
    v_permlane32_swap_b32 v64, v68
    v_permlane32_swap_b32 v66, v70
    v_add_f32 v64, v64, v68
    v_add_f32 v66, v66, v70
    s_nop 1
    v_permlane16_swap_b32 v64, v66
    v_add_f32 v64, v64, v66
    s_nop 1
    v_add_f32_dpp v64, v64, v64 row_ror:8 row_mask:0xf bank_mask:0xf
    ds_write_b32 v164, v64
    s_waitcnt lgkmcnt(0)
    s_barrier
    s_cmp_lg_u32 s3, 0
    s_cbranch_scc1 L_fin_5
    ds_read_b32 v32, v164 offset:0
    ds_read_b32 v33, v164 offset:256
    ds_read_b32 v34, v164 offset:512
    ds_read_b32 v35, v164 offset:768
    ds_read_b32 v36, v164 offset:1024
    ds_read_b32 v37, v164 offset:1280
    ds_read_b32 v38, v164 offset:1536
    ds_read_b32 v39, v164 offset:1792
    s_waitcnt lgkmcnt(0)
    v_add_f32 v32, v32, v33
    v_add_f32 v34, v34, v35
    v_add_f32 v36, v36, v37
    v_add_f32 v38, v38, v39
    v_add_f32 v32, v32, v34
    v_add_f32 v36, v36, v38
    v_cvt_pk_bf16_f32 v42, v32, v36
    v_and_b32 v43, 0xffff0000, v42
    v_lshlrev_b32 v42, 16, v42
    v_mul_f32 v42, v160, v42
    v_mul_f32 v43, v161, v43
    v_cvt_pk_bf16_f32 v42, v42, v43
    v_lshlrev_b32 v43, 16, v42
    v_and_b32 v42, 0xffff0000, v42
    v_add_f32 v42, v42, v43
    v_cvt_pk_bf16_f32 v42, v42, v42
    s_mov_b32 exec_lo, 0x00ff00ff
    s_mov_b32 exec_hi, 0x00ff00ff
    buffer_store_short v42, v162, s[40:43], s76 offen
    s_cmp_lg_u32 s2, 0
    s_cbranch_scc1 L_noep_31
    s_mov_b64 exec, 1
    v_mov_b32 v44, s35
    v_mov_b32 v45, 0
    buffer_store_dword v44, v45, s[36:39], 0 offen
L_noep_31:
    s_mov_b64 exec, -1
    s_branch L_fin_5
L_headabs_2:
    s_lshl_b32 s54, s54, 11
    s_add_u32 s54, s54, 36864
    v_lshrrev_b32 v48, 4, v0
    v_lshlrev_b32 v59, 9, v48
    v_and_b32 v49, 15, v0
    v_lshl_add_u32 v59, v49, 4, v59
    v_add_u32 v59, s54, v59
    s_mov_b32 s76, 16384
    v_bfe_u32 v50, v0, 3, 1
    v_lshlrev_b32 v60, 9, v50
    v_lshl_add_u32 v60, v48, 4, v60
    s_lshr_b32 s52, s3, 1
    s_lshl_b32 s52, s52, 7
    s_and_b32 s55, s3, 1
    s_lshl_b32 s55, s55, 6
    s_add_u32 s52, s52, s55
    s_add_u32 s52, s52, 49152
    v_add_u32 v60, s52, v60
    v_add_u32 v51, 50176, v1
    v_and_b32 v50, 7, v0
    v_cmp_lt_u32 vcc, 0, v50
    s_nop 1
    v_cndmask_b32 v60, v60, v51, vcc
    s_load_dword s34, s[32:33], 0
    s_mov_b32 s36, s32
    s_and_b32 s37, s33, 0xffff
    s_mov_b32 s38, 16777216
    s_mov_b32 s39, 0x20000
    s_lshl_b32 s52, s49, 21
    s_add_u32 s54, s6, s52
    s_addc_u32 s55, s7, 0
    s_mov_b32 s40, s54
    s_and_b32 s41, s55, 0xffff
    s_mov_b32 s42, 2097152
    s_mov_b32 s43, 0x20000
    s_add_u32 s54, s8, s52
    s_addc_u32 s55, s9, 0
    s_mov_b32 s44, s54
    s_and_b32 s45, s55, 0xffff
    s_mov_b32 s46, 2097152
    s_mov_b32 s47, 0x20000
    s_mul_i32 s52, s49, 65536
    s_lshl_b32 s60, s50, 3
    s_add_u32 s60, s60, s3
    s_lshl_b32 s60, s60, 12
    s_add_u32 s60, s60, s52
    s_mul_i32 s54, s50, 3
    s_add_u32 s54, s54, s3
    s_and_b32 s54, s54, 3
    s_lshl_b32 s61, s54, 10
    s_add_u32 s61, s61, s52
    s_add_u32 s61, s61, 1769472
    s_lshl_b32 s62, s49, 3
    s_add_u32 s62, s62, s54
    s_lshl_b32 s62, s62, 7
    s_add_u32 s62, s62, 159744
    s_lshl_b32 s52, s49, 10
    s_add_u32 s52, s52, 4096
    v_and_b32 v29, 15, v0
    v_lshlrev_b32 v29, 4, v29
    v_add_u32 v29, s52, v29
    s_mov_b32 s58, 1069066811
    v_mov_b32 v85, 0
    v_and_b32 v48, 1, v0
    v_mov_b32 v49, 0x0c0c0100
    v_mov_b32 v50, 0x01000c0c
    v_mov_b32 v51, 0x0c0c0302
    v_mov_b32 v52, 0x03020c0c
    v_mov_b32 v53, 0x0c0c0c0c
    v_cmp_eq_u32 vcc, 1, v48
    v_bfe_u32 v54, v0, 1, 2
    s_nop 0
    v_cndmask_b32 v49, v49, v50, vcc
    v_cndmask_b32 v51, v51, v52, vcc
    v_cmp_eq_u32 vcc, 0, v54
    s_nop 1
    v_cndmask_b32 v2, v53, v49, vcc
    v_cndmask_b32 v6, v53, v51, vcc
    v_cmp_eq_u32 vcc, 1, v54
    s_nop 1
    v_cndmask_b32 v3, v53, v49, vcc
    v_cndmask_b32 v7, v53, v51, vcc
    v_cmp_eq_u32 vcc, 2, v54
    s_nop 1
    v_cndmask_b32 v4, v53, v49, vcc
    v_cndmask_b32 v8, v53, v51, vcc
    v_cmp_eq_u32 vcc, 3, v54
    s_nop 1
    v_cndmask_b32 v5, v53, v49, vcc
    v_cndmask_b32 v9, v53, v51, vcc
    s_cmp_ge_u32 s48, 96
    s_cselect_b32 s63, 1, 0
    s_cselect_b32 s54, s24, s12
    s_cselect_b32 s55, s25, s13
    s_cselect_b32 s67, 2.0, 1.0
    s_mul_i32 s52, s63, 96
    s_sub_u32 s52, s48, s52
    s_mul_i32 s64, s52, 171
    s_lshr_b32 s64, s64, 9
    s_mul_i32 s65, s64, 3
    s_sub_u32 s65, s52, s65
    s_mov_b32 s68, s54
    s_and_b32 s69, s55, 0xffff
    s_mov_b32 s70, 4718592
    s_mov_b32 s71, 0x20000
    s_lshl_b32 s52, s64, 3
    s_add_u32 s52, s52, s3
    s_mul_i32 s52, s52, 18432
    s_mul_i32 s54, s65, 384
    s_add_u32 s52, s52, s54
    v_lshrrev_b32 v48, 4, v0
    v_mul_u32_u24 v30, 4608, v48
    v_add_u32 v30, s52, v30
    v_bfe_u32 v49, v0, 3, 1
    v_mul_u32_u24 v31, 1152, v49
    v_add_u32 v31, v31, v30
    v_and_b32 v50, 7, v0
    v_lshl_add_u32 v31, v50, 4, v31
    v_add_u32 v31, 256, v31
    v_and_b32 v51, 15, v0
    v_lshl_add_u32 v30, v51, 4, v30
    s_waitcnt lgkmcnt(0)
    s_mul_i32 s35, s34, 1664525
    s_add_u32 s35, s35, 1013904223
    s_waitcnt vmcnt(1)
    s_mov_b32 s51, 16384
    buffer_load_dwordx4 v[224:227], v28, s[72:75], s51 offen nt
    s_waitcnt vmcnt(1)
    s_mov_b32 s51, 24576
    buffer_load_dwordx4 v[228:231], v28, s[72:75], s51 offen nt
    s_waitcnt vmcnt(1)
    s_mov_b32 s51, 32768
    buffer_load_dwordx4 v[232:235], v28, s[72:75], s51 offen nt
    s_waitcnt vmcnt(1)
    s_mov_b32 s51, 40960
    buffer_load_dwordx4 v[236:239], v28, s[72:75], s51 offen nt
    s_waitcnt vmcnt(1)
    s_mov_b32 s51, 49152
    buffer_load_dwordx4 v[240:243], v28, s[72:75], s51 offen nt
    s_waitcnt vmcnt(1)
    s_mov_b32 s51, 57344
    buffer_load_dwordx4 v[244:247], v28, s[72:75], s51 offen nt
    s_add_u32 s51, s60, 0
    s_and_b32 s51, s51, 0x1fffff
    buffer_load_dwordx4 v[88:91], v1, s[40:43], s51 offen offset:0 nt
    buffer_load_dwordx4 v[92:95], v1, s[40:43], s51 offen offset:1024 nt
    s_waitcnt vmcnt(3)
    buffer_load_dwordx4 v[96:99], v1, s[40:43], s51 offen offset:2048 nt
    s_waitcnt vmcnt(3)
    buffer_load_dwordx4 v[100:103], v1, s[40:43], s51 offen offset:3072 nt
    s_waitcnt vmcnt(3)
    s_add_u32 s51, s60, 196608
    s_and_b32 s51, s51, 0x1fffff
    buffer_load_dwordx4 v[104:107], v1, s[40:43], s51 offen offset:0 nt
    s_waitcnt vmcnt(3)
    buffer_load_dwordx4 v[108:111], v1, s[40:43], s51 offen offset:1024 nt
    s_waitcnt vmcnt(3)
    buffer_load_dwordx4 v[112:115], v1, s[40:43], s51 offen offset:2048 nt
    s_waitcnt vmcnt(3)
    buffer_load_dwordx4 v[116:119], v1, s[40:43], s51 offen offset:3072 nt
    s_waitcnt vmcnt(3)
    s_add_u32 s51, s60, 393216
    s_and_b32 s51, s51, 0x1fffff
    buffer_load_dwordx4 v[120:123], v1, s[40:43], s51 offen offset:0 nt
    s_waitcnt vmcnt(3)
    buffer_load_dwordx4 v[124:127], v1, s[40:43], s51 offen offset:1024 nt
    s_waitcnt vmcnt(3)
    buffer_load_dwordx4 v[128:131], v1, s[40:43], s51 offen offset:2048 nt
    s_waitcnt vmcnt(3)
    buffer_load_dwordx4 v[132:135], v1, s[40:43], s51 offen offset:3072 nt
    s_waitcnt vmcnt(3)
    s_add_u32 s51, s60, 589824
    s_and_b32 s51, s51, 0x1fffff
    buffer_load_dwordx4 v[136:139], v1, s[40:43], s51 offen offset:0 nt
    buffer_load_dwordx4 v[10:13], v59, s[36:39], 0 offen offset:0 sc1
    buffer_load_dwordx4 v[14:17], v59, s[36:39], 0 offen offset:256 sc1
    buffer_load_dwordx4 v[18:21], v59, s[36:39], s76 offen offset:0 sc1
    buffer_load_dwordx4 v[22:25], v59, s[36:39], s76 offen offset:256 sc1
    s_waitcnt vmcnt(7)
    buffer_load_dwordx4 v[140:143], v1, s[40:43], s51 offen offset:1024 nt
    s_waitcnt vmcnt(7)
    buffer_load_dwordx4 v[144:147], v1, s[40:43], s51 offen offset:2048 nt
    s_waitcnt vmcnt(7)
    buffer_load_dwordx4 v[148:151], v1, s[40:43], s51 offen offset:3072 nt
    s_mov_b32 s53, 300000
    s_waitcnt vmcnt(3)
    v_xor_b32 v48, s35, v11
    v_bitop3_b32 v48, v48, v13, s35 bitop3:0xf6
    v_bitop3_b32 v48, v48, v15, s35 bitop3:0xf6
    v_bitop3_b32 v48, v48, v17, s35 bitop3:0xf6
    v_bitop3_b32 v48, v48, v19, s35 bitop3:0xf6
    v_bitop3_b32 v48, v48, v21, s35 bitop3:0xf6
    v_bitop3_b32 v48, v48, v23, s35 bitop3:0xf6
    v_bitop3_b32 v48, v48, v25, s35 bitop3:0xf6
    v_cmp_ne_u32 vcc, 0, v48
    s_cbranch_vccz L_gdone_33
L_gpoll_32:
    buffer_load_dwordx4 v[10:13], v59, s[36:39], 0 offen offset:0 sc1
    buffer_load_dwordx4 v[14:17], v59, s[36:39], 0 offen offset:256 sc1
    buffer_load_dwordx4 v[18:21], v59, s[36:39], s76 offen offset:0 sc1
    buffer_load_dwordx4 v[22:25], v59, s[36:39], s76 offen offset:256 sc1
    s_waitcnt vmcnt(0)
    v_xor_b32 v48, s35, v11
    v_bitop3_b32 v48, v48, v13, s35 bitop3:0xf6
    v_bitop3_b32 v48, v48, v15, s35 bitop3:0xf6
    v_bitop3_b32 v48, v48, v17, s35 bitop3:0xf6
    v_bitop3_b32 v48, v48, v19, s35 bitop3:0xf6
    v_bitop3_b32 v48, v48, v21, s35 bitop3:0xf6
    v_bitop3_b32 v48, v48, v23, s35 bitop3:0xf6
    v_bitop3_b32 v48, v48, v25, s35 bitop3:0xf6
    v_cmp_ne_u32 vcc, 0, v48
    s_cbranch_vccz L_gdone_33
    s_sleep 1
    s_sub_u32 s53, s53, 1
    s_cbranch_scc0 L_gpoll_32
    v_mov_b32 v62, 2
    v_mov_b32 v63, 0
    global_store_dword v63, v62, s[30:31] offset:64
    s_waitcnt vmcnt(0)
L_gdone_33:
    s_add_u32 s51, s60, 786432
    s_and_b32 s51, s51, 0x1fffff
    buffer_load_dwordx4 v[152:155], v1, s[40:43], s51 offen offset:0 nt
    v_dot2_f32_bf16 v36, v216, v10, 0
    v_dot2_f32_bf16 v37, v216, v18, 0
    v_dot2_f32_bf16 v38, v220, v10, 0
    v_dot2_f32_bf16 v39, v220, v18, 0
    v_dot2_f32_bf16 v40, v224, v10, 0
    v_dot2_f32_bf16 v41, v224, v18, 0
    v_dot2_f32_bf16 v42, v228, v10, 0
    v_dot2_f32_bf16 v43, v228, v18, 0
    v_dot2_f32_bf16 v36, v217, v12, v36
    v_dot2_f32_bf16 v37, v217, v20, v37
    v_dot2_f32_bf16 v38, v221, v12, v38
    v_dot2_f32_bf16 v39, v221, v20, v39
    v_dot2_f32_bf16 v40, v225, v12, v40
    v_dot2_f32_bf16 v41, v225, v20, v41
    v_dot2_f32_bf16 v42, v229, v12, v42
    v_dot2_f32_bf16 v43, v229, v20, v43
    v_dot2_f32_bf16 v36, v218, v14, v36
    v_dot2_f32_bf16 v37, v218, v22, v37
    v_dot2_f32_bf16 v38, v222, v14, v38
    v_dot2_f32_bf16 v39, v222, v22, v39
    v_dot2_f32_bf16 v40, v226, v14, v40
    v_dot2_f32_bf16 v41, v226, v22, v41
    v_dot2_f32_bf16 v42, v230, v14, v42
    v_dot2_f32_bf16 v43, v230, v22, v43
    v_dot2_f32_bf16 v36, v219, v16, v36
    v_dot2_f32_bf16 v37, v219, v24, v37
    v_dot2_f32_bf16 v38, v223, v16, v38
    v_dot2_f32_bf16 v39, v223, v24, v39
    v_dot2_f32_bf16 v40, v227, v16, v40
    v_dot2_f32_bf16 v41, v227, v24, v41
    v_dot2_f32_bf16 v42, v231, v16, v42
    v_dot2_f32_bf16 v43, v231, v24, v43
    v_add_f32_dpp v44, v36, v36 row_ror:8 row_mask:0xf bank_mask:0x3
    v_add_f32_dpp v45, v38, v38 row_ror:8 row_mask:0xf bank_mask:0x3
    v_add_f32_dpp v46, v40, v40 row_ror:8 row_mask:0xf bank_mask:0x3
    v_add_f32_dpp v47, v42, v42 row_ror:8 row_mask:0xf bank_mask:0x3
    v_add_f32_dpp v44, v37, v37 row_ror:8 row_mask:0xf bank_mask:0xc
    v_add_f32_dpp v45, v39, v39 row_ror:8 row_mask:0xf bank_mask:0xc
    v_add_f32_dpp v46, v41, v41 row_ror:8 row_mask:0xf bank_mask:0xc
    v_add_f32_dpp v47, v43, v43 row_ror:8 row_mask:0xf bank_mask:0xc
    v_add_f32_dpp v44, v44, v44 row_half_mirror row_mask:0xf bank_mask:0xf
    v_add_f32_dpp v45, v45, v45 row_half_mirror row_mask:0xf bank_mask:0xf
    v_add_f32_dpp v46, v46, v46 row_half_mirror row_mask:0xf bank_mask:0xf
    v_add_f32_dpp v47, v47, v47 row_half_mirror row_mask:0xf bank_mask:0xf
    v_add_f32_dpp v44, v44, v44 quad_perm:[1,0,3,2] row_mask:0xf bank_mask:0xf
    v_add_f32_dpp v45, v45, v45 quad_perm:[1,0,3,2] row_mask:0xf bank_mask:0xf
    v_add_f32_dpp v46, v46, v46 quad_perm:[1,0,3,2] row_mask:0xf bank_mask:0xf
    v_add_f32_dpp v47, v47, v47 quad_perm:[1,0,3,2] row_mask:0xf bank_mask:0xf
    v_add_f32_dpp v44, v44, v44 quad_perm:[2,3,0,1] row_mask:0xf bank_mask:0xf
    v_add_f32_dpp v45, v45, v45 quad_perm:[2,3,0,1] row_mask:0xf bank_mask:0xf
    v_add_f32_dpp v46, v46, v46 quad_perm:[2,3,0,1] row_mask:0xf bank_mask:0xf
    v_add_f32_dpp v47, v47, v47 quad_perm:[2,3,0,1] row_mask:0xf bank_mask:0xf
    s_waitcnt vmcnt(3)
    buffer_load_dwordx4 v[156:159], v1, s[40:43], s51 offen offset:1024 nt
    v_dot2_f32_bf16 v36, v232, v10, 0
    v_dot2_f32_bf16 v37, v232, v18, 0
    v_dot2_f32_bf16 v38, v236, v10, 0
    v_dot2_f32_bf16 v39, v236, v18, 0
    v_dot2_f32_bf16 v40, v240, v10, 0
    v_dot2_f32_bf16 v41, v240, v18, 0
    v_dot2_f32_bf16 v42, v244, v10, 0
    v_dot2_f32_bf16 v43, v244, v18, 0
    v_dot2_f32_bf16 v36, v233, v12, v36
    v_dot2_f32_bf16 v37, v233, v20, v37
    v_dot2_f32_bf16 v38, v237, v12, v38
    v_dot2_f32_bf16 v39, v237, v20, v39
    v_dot2_f32_bf16 v40, v241, v12, v40
    v_dot2_f32_bf16 v41, v241, v20, v41
    v_dot2_f32_bf16 v42, v245, v12, v42
    v_dot2_f32_bf16 v43, v245, v20, v43
    v_dot2_f32_bf16 v36, v234, v14, v36
    v_dot2_f32_bf16 v37, v234, v22, v37
    v_dot2_f32_bf16 v38, v238, v14, v38
    v_dot2_f32_bf16 v39, v238, v22, v39
    v_dot2_f32_bf16 v40, v242, v14, v40
    v_dot2_f32_bf16 v41, v242, v22, v41
    v_dot2_f32_bf16 v42, v246, v14, v42
    v_dot2_f32_bf16 v43, v246, v22, v43
    v_dot2_f32_bf16 v36, v235, v16, v36
    v_dot2_f32_bf16 v37, v235, v24, v37
    v_dot2_f32_bf16 v38, v239, v16, v38
    v_dot2_f32_bf16 v39, v239, v24, v39
    v_dot2_f32_bf16 v40, v243, v16, v40
    v_dot2_f32_bf16 v41, v243, v24, v41
    v_dot2_f32_bf16 v42, v247, v16, v42
    v_dot2_f32_bf16 v43, v247, v24, v43
    v_add_f32_dpp v48, v36, v36 row_ror:8 row_mask:0xf bank_mask:0x3
    v_add_f32_dpp v49, v38, v38 row_ror:8 row_mask:0xf bank_mask:0x3
    v_add_f32_dpp v50, v40, v40 row_ror:8 row_mask:0xf bank_mask:0x3
    v_add_f32_dpp v51, v42, v42 row_ror:8 row_mask:0xf bank_mask:0x3
    v_add_f32_dpp v48, v37, v37 row_ror:8 row_mask:0xf bank_mask:0xc
    v_add_f32_dpp v49, v39, v39 row_ror:8 row_mask:0xf bank_mask:0xc
    v_add_f32_dpp v50, v41, v41 row_ror:8 row_mask:0xf bank_mask:0xc
    v_add_f32_dpp v51, v43, v43 row_ror:8 row_mask:0xf bank_mask:0xc
    v_add_f32_dpp v48, v48, v48 row_half_mirror row_mask:0xf bank_mask:0xf
    v_add_f32_dpp v49, v49, v49 row_half_mirror row_mask:0xf bank_mask:0xf
    v_add_f32_dpp v50, v50, v50 row_half_mirror row_mask:0xf bank_mask:0xf
    v_add_f32_dpp v51, v51, v51 row_half_mirror row_mask:0xf bank_mask:0xf
    v_add_f32_dpp v48, v48, v48 quad_perm:[1,0,3,2] row_mask:0xf bank_mask:0xf
    v_add_f32_dpp v49, v49, v49 quad_perm:[1,0,3,2] row_mask:0xf bank_mask:0xf
    v_add_f32_dpp v50, v50, v50 quad_perm:[1,0,3,2] row_mask:0xf bank_mask:0xf
    v_add_f32_dpp v51, v51, v51 quad_perm:[1,0,3,2] row_mask:0xf bank_mask:0xf
    v_add_f32_dpp v48, v48, v48 quad_perm:[2,3,0,1] row_mask:0xf bank_mask:0xf
    v_add_f32_dpp v49, v49, v49 quad_perm:[2,3,0,1] row_mask:0xf bank_mask:0xf
    v_add_f32_dpp v50, v50, v50 quad_perm:[2,3,0,1] row_mask:0xf bank_mask:0xf
    v_add_f32_dpp v51, v51, v51 quad_perm:[2,3,0,1] row_mask:0xf bank_mask:0xf
    s_waitcnt vmcnt(3)
    buffer_load_dwordx4 v[160:163], v1, s[40:43], s51 offen offset:2048 nt
    v_cvt_pk_bf16_f32 v52, v44, v45
    v_cvt_pk_bf16_f32 v53, v46, v47
    v_cvt_pk_bf16_f32 v54, v48, v49
    v_cvt_pk_bf16_f32 v55, v50, v51
    ds_write_b128 v60, v[52:55]
    s_waitcnt lgkmcnt(0)
    s_barrier
    s_cmp_lg_u32 s3, 7
    s_cbranch_scc1 L_s2skip_35
    v_add_u32 v48, 49152, v1
    ds_read_b128 v[52:55], v48
    v_lshrrev_b32 v49, 5, v0
    v_lshlrev_b32 v49, 15, v49
    v_bfe_u32 v50, v0, 3, 2
    v_lshl_add_u32 v49, v50, 10, v49
    v_and_b32 v50, 7, v0
    v_lshl_add_u32 v49, v50, 4, v49
    s_lshr_b32 s52, s56, 1
    s_lshl_b32 s52, s52, 14
    s_and_b32 s54, s57, 3
    s_lshl_b32 s54, s54, 12
    s_add_u32 s52, s52, s54
    s_bfe_u32 s54, s57, 0x20002
    s_lshl_b32 s54, s54, 8
    s_add_u32 s52, s52, s54
    s_and_b32 s54, s56, 1
    s_lshl_b32 s54, s54, 7
    s_add_u32 s52, s52, s54
    s_add_u32 s52, s52, 69632
    s_waitcnt lgkmcnt(0)
    buffer_store_dwordx4 v[52:55], v49, s[36:39], s52 offen sc1
    s_lshl_b32 s54, s57, 7
    s_add_u32 s54, s54, 135168
    s_waitcnt vmcnt(0)
    v_mov_b32 v50, s35
    v_mov_b32 v51, 0
    s_mov_b64 exec, 1
    buffer_store_dword v50, v51, s[36:39], s54 offen sc1
    s_mov_b64 exec, -1
L_s2skip_35:
    s_waitcnt vmcnt(3)
    buffer_load_dwordx4 v[164:167], v1, s[40:43], s51 offen offset:3072 nt
    s_waitcnt vmcnt(3)
    s_add_u32 s51, s60, 983040
    s_and_b32 s51, s51, 0x1fffff
    buffer_load_dwordx4 v[168:171], v1, s[40:43], s51 offen offset:0 nt
    s_waitcnt vmcnt(3)
    buffer_load_dwordx4 v[172:175], v1, s[40:43], s51 offen offset:1024 nt
    s_branch L_merge_4
L_headq_1:
    v_lshrrev_b32 v48, 4, v0
    v_mul_u32_u24 v61, 36, v48
    v_bfe_u32 v50, v0, 3, 1
    v_mul_u32_u24 v50, 144, v50
    s_lshl_b32 s54, s3, 9
    s_add_u32 s54, s54, 57344
    v_add3_u32 v61, v61, v50, s54
    v_add_u32 v62, s54, v62
    s_cmp_eq_u32 s66, 0
    s_cselect_b32 s56, 32768, 0
    s_lshr_b32 s54, s57, 1
    s_lshl_b32 s54, s54, 9
    s_add_u32 s56, s56, s54
    s_and_b32 s54, s57, 1
    s_lshl_b32 s54, s54, 7
    s_add_u32 s56, s56, s54
    s_add_u32 s56, s56, 4096
    s_load_dword s34, s[32:33], 0
    s_mov_b32 s36, s32
    s_and_b32 s37, s33, 0xffff
    s_mov_b32 s38, 16777216
    s_mov_b32 s39, 0x20000
    s_lshl_b32 s52, s49, 21
    s_add_u32 s54, s6, s52
    s_addc_u32 s55, s7, 0
    s_mov_b32 s40, s54
    s_and_b32 s41, s55, 0xffff
    s_mov_b32 s42, 2097152
    s_mov_b32 s43, 0x20000
    s_add_u32 s54, s8, s52
    s_addc_u32 s55, s9, 0
    s_mov_b32 s44, s54
    s_and_b32 s45, s55, 0xffff
    s_mov_b32 s46, 2097152
    s_mov_b32 s47, 0x20000
    s_mul_i32 s52, s49, 65536
    s_lshl_b32 s60, s50, 3
    s_add_u32 s60, s60, s3
    s_lshl_b32 s60, s60, 12
    s_add_u32 s60, s60, s52
    s_mul_i32 s54, s50, 3
    s_add_u32 s54, s54, s3
    s_and_b32 s54, s54, 3
    s_lshl_b32 s61, s54, 10
    s_add_u32 s61, s61, s52
    s_add_u32 s61, s61, 1769472
    s_lshl_b32 s62, s49, 3
    s_add_u32 s62, s62, s54
    s_lshl_b32 s62, s62, 7
    s_add_u32 s62, s62, 159744
    s_lshl_b32 s52, s49, 10
    s_add_u32 s52, s52, 4096
    v_and_b32 v29, 15, v0
    v_lshlrev_b32 v29, 4, v29
    v_add_u32 v29, s52, v29
    s_mov_b32 s58, 1069066811
    v_mov_b32 v85, 0
    v_and_b32 v48, 1, v0
    v_mov_b32 v49, 0x0c0c0100
    v_mov_b32 v50, 0x01000c0c
    v_mov_b32 v51, 0x0c0c0302
    v_mov_b32 v52, 0x03020c0c
    v_mov_b32 v53, 0x0c0c0c0c
    v_cmp_eq_u32 vcc, 1, v48
    v_bfe_u32 v54, v0, 1, 2
    s_nop 0
    v_cndmask_b32 v49, v49, v50, vcc
    v_cndmask_b32 v51, v51, v52, vcc
    v_cmp_eq_u32 vcc, 0, v54
    s_nop 1
    v_cndmask_b32 v2, v53, v49, vcc
    v_cndmask_b32 v6, v53, v51, vcc
    v_cmp_eq_u32 vcc, 1, v54
    s_nop 1
    v_cndmask_b32 v3, v53, v49, vcc
    v_cndmask_b32 v7, v53, v51, vcc
    v_cmp_eq_u32 vcc, 2, v54
    s_nop 1
    v_cndmask_b32 v4, v53, v49, vcc
    v_cndmask_b32 v8, v53, v51, vcc
    v_cmp_eq_u32 vcc, 3, v54
    s_nop 1
    v_cndmask_b32 v5, v53, v49, vcc
    v_cndmask_b32 v9, v53, v51, vcc
    s_cmp_ge_u32 s48, 96
    s_cselect_b32 s63, 1, 0
    s_cselect_b32 s54, s24, s12
    s_cselect_b32 s55, s25, s13
    s_cselect_b32 s67, 2.0, 1.0
    s_mul_i32 s52, s63, 96
    s_sub_u32 s52, s48, s52
    s_mul_i32 s64, s52, 171
    s_lshr_b32 s64, s64, 9
    s_mul_i32 s65, s64, 3
    s_sub_u32 s65, s52, s65
    s_mov_b32 s68, s54
    s_and_b32 s69, s55, 0xffff
    s_mov_b32 s70, 4718592
    s_mov_b32 s71, 0x20000
    s_lshl_b32 s52, s64, 3
    s_add_u32 s52, s52, s3
    s_mul_i32 s52, s52, 18432
    s_mul_i32 s54, s65, 384
    s_add_u32 s52, s52, s54
    v_lshrrev_b32 v48, 4, v0
    v_mul_u32_u24 v30, 4608, v48
    v_add_u32 v30, s52, v30
    v_bfe_u32 v49, v0, 3, 1
    v_mul_u32_u24 v31, 1152, v49
    v_add_u32 v31, v31, v30
    v_and_b32 v50, 7, v0
    v_lshl_add_u32 v31, v50, 4, v31
    v_add_u32 v31, 256, v31
    v_and_b32 v51, 15, v0
    v_lshl_add_u32 v30, v51, 4, v30
    s_waitcnt lgkmcnt(0)
    s_mul_i32 s35, s34, 1664525
    s_add_u32 s35, s35, 1013904223
    s_cmp_eq_u32 s66, 0
    s_cbranch_scc1 L_y_36
    s_and_b32 s52, s57, 3
    s_lshr_b32 s54, s3, 1
    s_or_b32 s52, s52, s54
    s_cmp_lg_u32 s52, 0
    s_cbranch_scc1 L_nozero_37
    s_lshl_b32 s52, s3, 4
    s_lshr_b32 s54, s57, 2
    s_add_u32 s52, s52, s54
    s_lshl_b32 s52, s52, 10
    s_add_u32 s52, s52, 159744
    v_lshlrev_b32 v48, 7, v0
    s_mov_b64 exec, 0xff
    buffer_store_dword v85, v48, s[36:39], s52 offen sc1
    s_mov_b64 exec, -1
L_nozero_37:
    s_waitcnt vmcnt(1)
    s_mov_b32 s51, 32768
    buffer_load_dwordx4 v[220:223], v28, s[72:75], s51 offen nt
    s_waitcnt vmcnt(1)
    s_mov_b32 s51, 49152
    buffer_load_dwordx4 v[224:227], v28, s[72:75], s51 offen nt
L_y_36:
    v_mov_b32 v32, 0
    v_mov_b32 v33, 0
    v_mov_b32 v34, 0
    v_mov_b32 v35, 0
    v_mov_b32 v36, 0
    v_mov_b32 v37, 0
    v_mov_b32 v38, 0
    v_mov_b32 v39, 0
    s_waitcnt vmcnt(4)
    ds_write_b64 v62, v[20:21]
    ds_read2_b32 v[10:11], v61 offset0:0 offset1:1
    ds_read2_b32 v[12:13], v61 offset0:2 offset1:3
    ds_read2_b32 v[14:15], v61 offset0:4 offset1:5
    ds_read2_b32 v[16:17], v61 offset0:6 offset1:7
    ds_read_b32 v18, v61 offset:32
    s_waitcnt lgkmcnt(0)
    v_perm_b32 v40, v10, v10, v2
    v_perm_b32 v41, v10, v10, v3
    v_perm_b32 v42, v10, v10, v4
    v_perm_b32 v43, v10, v10, v5
    v_perm_b32 v44, v10, v10, v6
    v_perm_b32 v45, v10, v10, v7
    v_perm_b32 v46, v10, v10, v8
    v_perm_b32 v47, v10, v10, v9
    s_waitcnt vmcnt(3)
    s_cmp_eq_u32 s66, 0
    s_cbranch_scc1 L_y_38
    s_waitcnt vmcnt(1)
L_y_38:
    s_mov_b32 s51, 65536
    buffer_load_dwordx4 v[228:231], v28, s[72:75], s51 offen nt
    v_mfma_f32_16x16x32_bf16 v[32:35], v[212:215], v[40:43], v[32:35]
    v_mfma_f32_16x16x32_bf16 v[36:39], v[212:215], v[44:47], v[36:39]
    v_perm_b32 v40, v11, v11, v2
    v_perm_b32 v41, v11, v11, v3
    v_perm_b32 v42, v11, v11, v4
    v_perm_b32 v43, v11, v11, v5
    v_perm_b32 v44, v11, v11, v6
    v_perm_b32 v45, v11, v11, v7
    v_perm_b32 v46, v11, v11, v8
    v_perm_b32 v47, v11, v11, v9
    s_waitcnt vmcnt(3)
    s_cmp_eq_u32 s66, 0
    s_cbranch_scc1 L_y_39
    s_waitcnt vmcnt(1)
L_y_39:
    s_mov_b32 s51, 81920
    buffer_load_dwordx4 v[232:235], v28, s[72:75], s51 offen nt
    v_mfma_f32_16x16x32_bf16 v[32:35], v[216:219], v[40:43], v[32:35]
    v_mfma_f32_16x16x32_bf16 v[36:39], v[216:219], v[44:47], v[36:39]
    v_perm_b32 v40, v12, v12, v2
    v_perm_b32 v41, v12, v12, v3
    v_perm_b32 v42, v12, v12, v4
    v_perm_b32 v43, v12, v12, v5
    v_perm_b32 v44, v12, v12, v6
    v_perm_b32 v45, v12, v12, v7
    v_perm_b32 v46, v12, v12, v8
    v_perm_b32 v47, v12, v12, v9
    s_waitcnt vmcnt(3)
    s_cmp_eq_u32 s66, 0
    s_cbranch_scc1 L_y_40
    s_waitcnt vmcnt(1)
L_y_40:
    s_mov_b32 s51, 98304
    buffer_load_dwordx4 v[236:239], v28, s[72:75], s51 offen nt
    v_mfma_f32_16x16x32_bf16 v[32:35], v[220:223], v[40:43], v[32:35]
    v_mfma_f32_16x16x32_bf16 v[36:39], v[220:223], v[44:47], v[36:39]
    v_perm_b32 v40, v13, v13, v2
    v_perm_b32 v41, v13, v13, v3
    v_perm_b32 v42, v13, v13, v4
    v_perm_b32 v43, v13, v13, v5
    v_perm_b32 v44, v13, v13, v6
    v_perm_b32 v45, v13, v13, v7
    v_perm_b32 v46, v13, v13, v8
    v_perm_b32 v47, v13, v13, v9
    s_waitcnt vmcnt(3)
    s_cmp_eq_u32 s66, 0
    s_cbranch_scc1 L_y_41
    s_waitcnt vmcnt(1)
L_y_41:
    s_mov_b32 s51, 114688
    buffer_load_dwordx4 v[240:243], v28, s[72:75], s51 offen nt
    v_mfma_f32_16x16x32_bf16 v[32:35], v[224:227], v[40:43], v[32:35]
    v_mfma_f32_16x16x32_bf16 v[36:39], v[224:227], v[44:47], v[36:39]
    v_perm_b32 v40, v14, v14, v2
    v_perm_b32 v41, v14, v14, v3
    v_perm_b32 v42, v14, v14, v4
    v_perm_b32 v43, v14, v14, v5
    v_perm_b32 v44, v14, v14, v6
    v_perm_b32 v45, v14, v14, v7
    v_perm_b32 v46, v14, v14, v8
    v_perm_b32 v47, v14, v14, v9
    s_waitcnt vmcnt(3)
    s_mov_b32 s51, 131072
    buffer_load_dwordx4 v[244:247], v28, s[72:75], s51 offen nt
    v_mfma_f32_16x16x32_bf16 v[32:35], v[228:231], v[40:43], v[32:35]
    v_mfma_f32_16x16x32_bf16 v[36:39], v[228:231], v[44:47], v[36:39]
    v_perm_b32 v40, v15, v15, v2
    v_perm_b32 v41, v15, v15, v3
    v_perm_b32 v42, v15, v15, v4
    v_perm_b32 v43, v15, v15, v5
    v_perm_b32 v44, v15, v15, v6
    v_perm_b32 v45, v15, v15, v7
    v_perm_b32 v46, v15, v15, v8
    v_perm_b32 v47, v15, v15, v9
    s_waitcnt vmcnt(3)
    s_add_u32 s51, s60, 0
    s_and_b32 s51, s51, 0x1fffff
    buffer_load_dwordx4 v[88:91], v1, s[40:43], s51 offen offset:0 nt
    v_mfma_f32_16x16x32_bf16 v[32:35], v[232:235], v[40:43], v[32:35]
    v_mfma_f32_16x16x32_bf16 v[36:39], v[232:235], v[44:47], v[36:39]
    v_perm_b32 v40, v16, v16, v2
    v_perm_b32 v41, v16, v16, v3
    v_perm_b32 v42, v16, v16, v4
    v_perm_b32 v43, v16, v16, v5
    v_perm_b32 v44, v16, v16, v6
    v_perm_b32 v45, v16, v16, v7
    v_perm_b32 v46, v16, v16, v8
    v_perm_b32 v47, v16, v16, v9
    s_waitcnt vmcnt(3)
    buffer_load_dwordx4 v[92:95], v1, s[40:43], s51 offen offset:1024 nt
    v_mfma_f32_16x16x32_bf16 v[32:35], v[236:239], v[40:43], v[32:35]
    v_mfma_f32_16x16x32_bf16 v[36:39], v[236:239], v[44:47], v[36:39]
    v_perm_b32 v40, v17, v17, v2
    v_perm_b32 v41, v17, v17, v3
    v_perm_b32 v42, v17, v17, v4
    v_perm_b32 v43, v17, v17, v5
    v_perm_b32 v44, v17, v17, v6
    v_perm_b32 v45, v17, v17, v7
    v_perm_b32 v46, v17, v17, v8
    v_perm_b32 v47, v17, v17, v9
    s_waitcnt vmcnt(3)
    buffer_load_dwordx4 v[96:99], v1, s[40:43], s51 offen offset:2048 nt
    v_mfma_f32_16x16x32_bf16 v[32:35], v[240:243], v[40:43], v[32:35]
    v_mfma_f32_16x16x32_bf16 v[36:39], v[240:243], v[44:47], v[36:39]
    v_perm_b32 v40, v18, v18, v2
    v_perm_b32 v41, v18, v18, v3
    v_perm_b32 v42, v18, v18, v4
    v_perm_b32 v43, v18, v18, v5
    v_perm_b32 v44, v18, v18, v6
    v_perm_b32 v45, v18, v18, v7
    v_perm_b32 v46, v18, v18, v8
    v_perm_b32 v47, v18, v18, v9
    s_waitcnt vmcnt(3)
    buffer_load_dwordx4 v[100:103], v1, s[40:43], s51 offen offset:3072 nt
    v_mfma_f32_16x16x32_bf16 v[32:35], v[244:247], v[40:43], v[32:35]
    v_mfma_f32_16x16x32_bf16 v[36:39], v[244:247], v[44:47], v[36:39]
    v_cmp_lt_u32 vcc, 31, v0
    s_lshl_b32 s52, s3, 10
    s_add_u32 s52, s52, 32768
    v_add_u32 v48, s52, v1
    s_nop 3
    v_cndmask_b32 v32, v32, v36, vcc
    v_cndmask_b32 v33, v33, v37, vcc
    v_cndmask_b32 v34, v34, v38, vcc
    v_cndmask_b32 v35, v35, v39, vcc
    ds_write_b128 v48, v[32:35]
    s_waitcnt lgkmcnt(0)
    s_barrier
    s_cmp_ge_u32 s3, 2
    s_cbranch_scc1 L_s1skip_42
    v_and_b32 v48, 7, v0
    v_lshlrev_b32 v48, 4, v48
    v_bfe_u32 v49, v0, 3, 2
    v_lshl_add_u32 v48, v49, 2, v48
    v_lshrrev_b32 v49, 5, v0
    v_lshl_add_u32 v48, v49, 8, v48
    s_lshl_b32 s52, s3, 7
    s_add_u32 s52, s52, 32768
    v_add_u32 v48, s52, v48
    ds_read_b32 v32, v48 offset:0
    ds_read_b32 v33, v48 offset:512
    ds_read_b32 v34, v48 offset:1024
    ds_read_b32 v35, v48 offset:1536
    ds_read_b32 v36, v48 offset:2048
    ds_read_b32 v37, v48 offset:2560
    ds_read_b32 v38, v48 offset:3072
    ds_read_b32 v39, v48 offset:3584
    ds_read_b32 v40, v48 offset:4096
    ds_read_b32 v41, v48 offset:4608
    ds_read_b32 v42, v48 offset:5120
    ds_read_b32 v43, v48 offset:5632
    s_waitcnt lgkmcnt(0)
    ds_read_b32 v44, v48 offset:6144
    ds_read_b32 v45, v48 offset:6656
    ds_read_b32 v46, v48 offset:7168
    ds_read_b32 v47, v48 offset:7680
    s_lshl_b32 s52, s3, 14
    s_add_u32 s52, s52, s56
    v_mov_b32 v53, s35
    v_bfe_u32 v50, v0, 2, 1
    v_lshlrev_b32 v50, 8, v50
    v_lshrrev_b32 v51, 3, v0
    v_lshl_add_u32 v50, v51, 4, v50
    v_bfe_u32 v51, v0, 1, 1
    v_lshl_add_u32 v50, v51, 3, v50
    s_waitcnt lgkmcnt(0)
    v_add_f32 v32, v32, v40
    v_add_f32 v33, v33, v41
    v_add_f32 v34, v34, v42
    v_add_f32 v35, v35, v43
    v_add_f32 v36, v36, v44
    v_add_f32 v37, v37, v45
    v_add_f32 v38, v38, v46
    v_add_f32 v39, v39, v47
    v_add_f32 v32, v32, v36
    v_add_f32 v33, v33, v37
    v_add_f32 v34, v34, v38
    v_add_f32 v35, v35, v39
    v_add_f32 v32, v32, v34
    v_add_f32 v33, v33, v35
    v_add_f32 v32, v32, v33
    s_cmp_eq_u32 s66, 0
    s_cbranch_scc1 L_s1w_43
    s_waitcnt vmcnt(0)
L_s1w_43:
    v_mov_b32_dpp v33, v32 quad_perm:[1,0,3,2] row_mask:0xf bank_mask:0xf
    v_cvt_pk_bf16_f32 v52, v32, v33
    s_mov_b32 exec_lo, 0x55555555
    s_mov_b32 exec_hi, 0x55555555
    buffer_store_dwordx2 v[52:53], v50, s[36:39], s52 offen sc1
    s_mov_b64 exec, -1
L_s1skip_42:
    s_waitcnt vmcnt(3)
    s_add_u32 s51, s60, 196608
    s_and_b32 s51, s51, 0x1fffff
    buffer_load_dwordx4 v[104:107], v1, s[40:43], s51 offen offset:0 nt
    s_waitcnt vmcnt(3)
    buffer_load_dwordx4 v[108:111], v1, s[40:43], s51 offen offset:1024 nt
    s_waitcnt vmcnt(3)
    buffer_load_dwordx4 v[112:115], v1, s[40:43], s51 offen offset:2048 nt
    s_waitcnt vmcnt(3)
    buffer_load_dwordx4 v[116:119], v1, s[40:43], s51 offen offset:3072 nt
    s_waitcnt vmcnt(3)
    s_add_u32 s51, s60, 393216
    s_and_b32 s51, s51, 0x1fffff
    buffer_load_dwordx4 v[120:123], v1, s[40:43], s51 offen offset:0 nt
    s_waitcnt vmcnt(3)
    buffer_load_dwordx4 v[124:127], v1, s[40:43], s51 offen offset:1024 nt
    s_waitcnt vmcnt(3)
    buffer_load_dwordx4 v[128:131], v1, s[40:43], s51 offen offset:2048 nt
    s_waitcnt vmcnt(3)
    buffer_load_dwordx4 v[132:135], v1, s[40:43], s51 offen offset:3072 nt
    s_waitcnt vmcnt(3)
    s_add_u32 s51, s60, 589824
    s_and_b32 s51, s51, 0x1fffff
    buffer_load_dwordx4 v[136:139], v1, s[40:43], s51 offen offset:0 nt
    s_waitcnt vmcnt(3)
    buffer_load_dwordx4 v[140:143], v1, s[40:43], s51 offen offset:1024 nt
    s_waitcnt vmcnt(3)
    buffer_load_dwordx4 v[144:147], v1, s[40:43], s51 offen offset:2048 nt
    s_waitcnt vmcnt(3)
    buffer_load_dwordx4 v[148:151], v1, s[40:43], s51 offen offset:3072 nt
    s_waitcnt vmcnt(3)
    s_add_u32 s51, s60, 786432
    s_and_b32 s51, s51, 0x1fffff
    buffer_load_dwordx4 v[152:155], v1, s[40:43], s51 offen offset:0 nt
    s_waitcnt vmcnt(3)
    buffer_load_dwordx4 v[156:159], v1, s[40:43], s51 offen offset:1024 nt
    s_waitcnt vmcnt(3)
    buffer_load_dwordx4 v[160:163], v1, s[40:43], s51 offen offset:2048 nt
    s_waitcnt vmcnt(3)
    buffer_load_dwordx4 v[164:167], v1, s[40:43], s51 offen offset:3072 nt
    s_waitcnt vmcnt(3)
    s_add_u32 s51, s60, 983040
    s_and_b32 s51, s51, 0x1fffff
    buffer_load_dwordx4 v[168:171], v1, s[40:43], s51 offen offset:0 nt
    s_waitcnt vmcnt(3)
    buffer_load_dwordx4 v[172:175], v1, s[40:43], s51 offen offset:1024 nt
L_merge_4:
    v_mov_b32 v26, 4286578688
    v_mov_b32 v27, 0
    v_mov_b32 v32, 0
    v_mov_b32 v33, 0
    v_mov_b32 v34, 0
    v_mov_b32 v35, 0
    buffer_load_dwordx4 v[10:13], v29, s[36:39], 0 offen offset:0 sc1
    buffer_load_dwordx4 v[14:17], v29, s[36:39], 0 offen offset:256 sc1
    buffer_load_dwordx4 v[18:21], v29, s[36:39], 0 offen offset:512 sc1
    buffer_load_dwordx4 v[22:25], v29, s[36:39], 0 offen offset:768 sc1
    s_waitcnt vmcnt(7)
    buffer_load_dwordx4 v[176:179], v1, s[40:43], s51 offen offset:2048 nt
    s_waitcnt vmcnt(7)
    buffer_load_dwordx4 v[180:183], v1, s[40:43], s51 offen offset:3072 nt
    s_waitcnt vmcnt(7)
    s_add_u32 s51, s60, 1179648
    s_and_b32 s51, s51, 0x1fffff
    buffer_load_dwordx4 v[184:187], v1, s[40:43], s51 offen offset:0 nt
    s_waitcnt vmcnt(7)
    buffer_load_dwordx4 v[188:191], v1, s[40:43], s51 offen offset:1024 nt
    s_mov_b32 s53, 300000
    s_waitcnt vmcnt(4)
    v_xor_b32 v48, s35, v11
    v_bitop3_b32 v48, v48, v13, s35 bitop3:0xf6
    v_bitop3_b32 v48, v48, v15, s35 bitop3:0xf6
    v_bitop3_b32 v48, v48, v17, s35 bitop3:0xf6
    v_bitop3_b32 v48, v48, v19, s35 bitop3:0xf6
    v_bitop3_b32 v48, v48, v21, s35 bitop3:0xf6
    v_bitop3_b32 v48, v48, v23, s35 bitop3:0xf6
    v_bitop3_b32 v48, v48, v25, s35 bitop3:0xf6
    v_cmp_ne_u32 vcc, 0, v48
    s_cbranch_vccz L_gdone_45
L_gpoll_44:
    buffer_load_dwordx4 v[10:13], v29, s[36:39], 0 offen offset:0 sc1
    buffer_load_dwordx4 v[14:17], v29, s[36:39], 0 offen offset:256 sc1
    buffer_load_dwordx4 v[18:21], v29, s[36:39], 0 offen offset:512 sc1
    buffer_load_dwordx4 v[22:25], v29, s[36:39], 0 offen offset:768 sc1
    s_waitcnt vmcnt(0)
    v_xor_b32 v48, s35, v11
    v_bitop3_b32 v48, v48, v13, s35 bitop3:0xf6
    v_bitop3_b32 v48, v48, v15, s35 bitop3:0xf6
    v_bitop3_b32 v48, v48, v17, s35 bitop3:0xf6
    v_bitop3_b32 v48, v48, v19, s35 bitop3:0xf6
    v_bitop3_b32 v48, v48, v21, s35 bitop3:0xf6
    v_bitop3_b32 v48, v48, v23, s35 bitop3:0xf6
    v_bitop3_b32 v48, v48, v25, s35 bitop3:0xf6
    v_cmp_ne_u32 vcc, 0, v48
    s_cbranch_vccz L_gdone_45
    s_sub_u32 s53, s53, 1
    s_cbranch_scc0 L_gpoll_44
    v_mov_b32 v62, 1
    v_mov_b32 v63, 0
    global_store_dword v63, v62, s[30:31] offset:64
    s_waitcnt vmcnt(0)
L_gdone_45:
    s_lshl_b32 s52, s3, 10
    s_add_u32 s52, s52, 65536
    v_add_u32 v83, s52, v1
    v_bfe_u32 v84, v0, 3, 1
    v_lshlrev_b32 v84, 6, v84
    s_lshl_b32 s52, s3, 3
    s_add_u32 s52, s52, 73728
    v_add_u32 v84, s52, v84
    v_and_b32 v28, 7, v0
    v_lshlrev_b32 v28, 4, v28
    v_bfe_u32 v48, v0, 3, 2
    v_lshl_add_u32 v28, v48, 2, v28
    v_lshrrev_b32 v48, 5, v0
    v_lshl_add_u32 v28, v48, 8, v28
    s_and_b32 s52, s3, 1
    s_lshl_b32 s52, s52, 9
    s_lshr_b32 s54, s3, 1
    s_lshl_b32 s54, s54, 7
    s_add_u32 s52, s52, s54
    s_add_u32 s52, s52, 65536
    v_add_u32 v28, s52, v28
    s_lshr_b32 s52, s3, 1
    s_lshl_b32 s54, s49, 1
    s_add_u32 s52, s52, s54
    s_lshl_b32 s52, s52, 3
    s_add_u32 s52, s52, s50
    s_lshl_b32 s52, s52, 9
    s_add_u32 s78, s52, 196608
    s_and_b32 s54, s3, 1
    s_lshl_b32 s55, s54, 8
    v_lshlrev_b32 v63, 2, v0
    v_add_u32 v63, s55, v63
    s_lshr_b32 s55, s3, 1
    s_lshl_b32 s55, s55, 6
    s_add_u32 s55, s55, 73728
    v_mov_b32 v29, s55
    s_waitcnt vmcnt(3)
    buffer_load_dwordx4 v[192:195], v1, s[40:43], s51 offen offset:2048 nt
    v_dot2_f32_bf16 v36, v88, v10, 0
    v_dot2_f32_bf16 v37, v88, v18, 0
    v_dot2_f32_bf16 v38, v92, v10, 0
    v_dot2_f32_bf16 v39, v92, v18, 0
    v_dot2_f32_bf16 v40, v96, v10, 0
    v_dot2_f32_bf16 v41, v96, v18, 0
    v_dot2_f32_bf16 v42, v100, v10, 0
    v_dot2_f32_bf16 v43, v100, v18, 0
    v_dot2_f32_bf16 v36, v89, v12, v36
    v_dot2_f32_bf16 v37, v89, v20, v37
    v_dot2_f32_bf16 v38, v93, v12, v38
    v_dot2_f32_bf16 v39, v93, v20, v39
    v_dot2_f32_bf16 v40, v97, v12, v40
    v_dot2_f32_bf16 v41, v97, v20, v41
    v_dot2_f32_bf16 v42, v101, v12, v42
    v_dot2_f32_bf16 v43, v101, v20, v43
    v_dot2_f32_bf16 v36, v90, v14, v36
    v_dot2_f32_bf16 v37, v90, v22, v37
    v_dot2_f32_bf16 v38, v94, v14, v38
    v_dot2_f32_bf16 v39, v94, v22, v39
    v_dot2_f32_bf16 v40, v98, v14, v40
    v_dot2_f32_bf16 v41, v98, v22, v41
    v_dot2_f32_bf16 v42, v102, v14, v42
    v_dot2_f32_bf16 v43, v102, v22, v43
    v_dot2_f32_bf16 v36, v91, v16, v36
    v_dot2_f32_bf16 v37, v91, v24, v37
    v_dot2_f32_bf16 v38, v95, v16, v38
    v_dot2_f32_bf16 v39, v95, v24, v39
    v_dot2_f32_bf16 v40, v99, v16, v40
    v_dot2_f32_bf16 v41, v99, v24, v41
    v_dot2_f32_bf16 v42, v103, v16, v42
    v_dot2_f32_bf16 v43, v103, v24, v43
    v_add_f32_dpp v44, v36, v36 row_ror:8 row_mask:0xf bank_mask:0x3
    v_add_f32_dpp v45, v38, v38 row_ror:8 row_mask:0xf bank_mask:0x3
    v_add_f32_dpp v46, v40, v40 row_ror:8 row_mask:0xf bank_mask:0x3
    v_add_f32_dpp v47, v42, v42 row_ror:8 row_mask:0xf bank_mask:0x3
    v_add_f32_dpp v44, v37, v37 row_ror:8 row_mask:0xf bank_mask:0xc
    v_add_f32_dpp v45, v39, v39 row_ror:8 row_mask:0xf bank_mask:0xc
    v_add_f32_dpp v46, v41, v41 row_ror:8 row_mask:0xf bank_mask:0xc
    v_add_f32_dpp v47, v43, v43 row_ror:8 row_mask:0xf bank_mask:0xc
    v_add_f32_dpp v44, v44, v44 row_half_mirror row_mask:0xf bank_mask:0xf
    v_add_f32_dpp v45, v45, v45 row_half_mirror row_mask:0xf bank_mask:0xf
    v_add_f32_dpp v46, v46, v46 row_half_mirror row_mask:0xf bank_mask:0xf
    v_add_f32_dpp v47, v47, v47 row_half_mirror row_mask:0xf bank_mask:0xf
    v_add_f32_dpp v44, v44, v44 quad_perm:[1,0,3,2] row_mask:0xf bank_mask:0xf
    v_add_f32_dpp v45, v45, v45 quad_perm:[1,0,3,2] row_mask:0xf bank_mask:0xf
    v_add_f32_dpp v46, v46, v46 quad_perm:[1,0,3,2] row_mask:0xf bank_mask:0xf
    v_add_f32_dpp v47, v47, v47 quad_perm:[1,0,3,2] row_mask:0xf bank_mask:0xf
    v_add_f32_dpp v44, v44, v44 quad_perm:[2,3,0,1] row_mask:0xf bank_mask:0xf
    v_add_f32_dpp v45, v45, v45 quad_perm:[2,3,0,1] row_mask:0xf bank_mask:0xf
    v_add_f32_dpp v46, v46, v46 quad_perm:[2,3,0,1] row_mask:0xf bank_mask:0xf
    v_add_f32_dpp v47, v47, v47 quad_perm:[2,3,0,1] row_mask:0xf bank_mask:0xf
    v_cvt_pk_bf16_f32 v48, v44, v45
    v_cvt_pk_bf16_f32 v50, v46, v47
    v_max3_f32 v26, v26, v44, v45
    v_and_b32 v49, 0xffff0000, v48
    v_lshlrev_b32 v48, 16, v48
    v_and_b32 v51, 0xffff0000, v50
    v_lshlrev_b32 v50, 16, v50
    v_max3_f32 v26, v26, v46, v47
    v_mul_f32 v48, 1035273459, v48
    v_mul_f32 v49, 1035273459, v49
    v_mul_f32 v50, 1035273459, v50
    v_mul_f32 v51, 1035273459, v51
    v_cvt_pk_bf16_f32 v64, v48, v49
    v_cvt_pk_bf16_f32 v65, v50, v51
    s_waitcnt vmcnt(3)
    buffer_load_dwordx4 v[196:199], v1, s[40:43], s51 offen offset:3072 nt
    v_dot2_f32_bf16 v36, v104, v10, 0
    v_dot2_f32_bf16 v37, v104, v18, 0
    v_dot2_f32_bf16 v38, v108, v10, 0
    v_dot2_f32_bf16 v39, v108, v18, 0
    v_dot2_f32_bf16 v40, v112, v10, 0
    v_dot2_f32_bf16 v41, v112, v18, 0
    v_dot2_f32_bf16 v42, v116, v10, 0
    v_dot2_f32_bf16 v43, v116, v18, 0
    v_dot2_f32_bf16 v36, v105, v12, v36
    v_dot2_f32_bf16 v37, v105, v20, v37
    v_dot2_f32_bf16 v38, v109, v12, v38
    v_dot2_f32_bf16 v39, v109, v20, v39
    v_dot2_f32_bf16 v40, v113, v12, v40
    v_dot2_f32_bf16 v41, v113, v20, v41
    v_dot2_f32_bf16 v42, v117, v12, v42
    v_dot2_f32_bf16 v43, v117, v20, v43
    v_dot2_f32_bf16 v36, v106, v14, v36
    v_dot2_f32_bf16 v37, v106, v22, v37
    v_dot2_f32_bf16 v38, v110, v14, v38
    v_dot2_f32_bf16 v39, v110, v22, v39
    v_dot2_f32_bf16 v40, v114, v14, v40
    v_dot2_f32_bf16 v41, v114, v22, v41
    v_dot2_f32_bf16 v42, v118, v14, v42
    v_dot2_f32_bf16 v43, v118, v22, v43
    v_dot2_f32_bf16 v36, v107, v16, v36
    v_dot2_f32_bf16 v37, v107, v24, v37
    v_dot2_f32_bf16 v38, v111, v16, v38
    v_dot2_f32_bf16 v39, v111, v24, v39
    v_dot2_f32_bf16 v40, v115, v16, v40
    v_dot2_f32_bf16 v41, v115, v24, v41
    v_dot2_f32_bf16 v42, v119, v16, v42
    v_dot2_f32_bf16 v43, v119, v24, v43
    v_add_f32_dpp v44, v36, v36 row_ror:8 row_mask:0xf bank_mask:0x3
    v_add_f32_dpp v45, v38, v38 row_ror:8 row_mask:0xf bank_mask:0x3
    v_add_f32_dpp v46, v40, v40 row_ror:8 row_mask:0xf bank_mask:0x3
    v_add_f32_dpp v47, v42, v42 row_ror:8 row_mask:0xf bank_mask:0x3
    v_add_f32_dpp v44, v37, v37 row_ror:8 row_mask:0xf bank_mask:0xc
    v_add_f32_dpp v45, v39, v39 row_ror:8 row_mask:0xf bank_mask:0xc
    v_add_f32_dpp v46, v41, v41 row_ror:8 row_mask:0xf bank_mask:0xc
    v_add_f32_dpp v47, v43, v43 row_ror:8 row_mask:0xf bank_mask:0xc
    v_add_f32_dpp v44, v44, v44 row_half_mirror row_mask:0xf bank_mask:0xf
    v_add_f32_dpp v45, v45, v45 row_half_mirror row_mask:0xf bank_mask:0xf
    v_add_f32_dpp v46, v46, v46 row_half_mirror row_mask:0xf bank_mask:0xf
    v_add_f32_dpp v47, v47, v47 row_half_mirror row_mask:0xf bank_mask:0xf
    v_add_f32_dpp v44, v44, v44 quad_perm:[1,0,3,2] row_mask:0xf bank_mask:0xf
    v_add_f32_dpp v45, v45, v45 quad_perm:[1,0,3,2] row_mask:0xf bank_mask:0xf
    v_add_f32_dpp v46, v46, v46 quad_perm:[1,0,3,2] row_mask:0xf bank_mask:0xf
    v_add_f32_dpp v47, v47, v47 quad_perm:[1,0,3,2] row_mask:0xf bank_mask:0xf
    v_add_f32_dpp v44, v44, v44 quad_perm:[2,3,0,1] row_mask:0xf bank_mask:0xf
    v_add_f32_dpp v45, v45, v45 quad_perm:[2,3,0,1] row_mask:0xf bank_mask:0xf
    v_add_f32_dpp v46, v46, v46 quad_perm:[2,3,0,1] row_mask:0xf bank_mask:0xf
    v_add_f32_dpp v47, v47, v47 quad_perm:[2,3,0,1] row_mask:0xf bank_mask:0xf
    v_cvt_pk_bf16_f32 v48, v44, v45
    v_cvt_pk_bf16_f32 v50, v46, v47
    v_max3_f32 v26, v26, v44, v45
    v_and_b32 v49, 0xffff0000, v48
    v_lshlrev_b32 v48, 16, v48
    v_and_b32 v51, 0xffff0000, v50
    v_lshlrev_b32 v50, 16, v50
    v_max3_f32 v26, v26, v46, v47
    v_mul_f32 v48, 1035273459, v48
    v_mul_f32 v49, 1035273459, v49
    v_mul_f32 v50, 1035273459, v50
    v_mul_f32 v51, 1035273459, v51
    v_cvt_pk_bf16_f32 v66, v48, v49
    v_cvt_pk_bf16_f32 v67, v50, v51
    s_waitcnt vmcnt(3)
    s_add_u32 s51, s60, 1376256
    s_and_b32 s51, s51, 0x1fffff
    buffer_load_dwordx4 v[200:203], v1, s[40:43], s51 offen offset:0 nt
    v_dot2_f32_bf16 v36, v120, v10, 0
    v_dot2_f32_bf16 v37, v120, v18, 0
    v_dot2_f32_bf16 v38, v124, v10, 0
    v_dot2_f32_bf16 v39, v124, v18, 0
    v_dot2_f32_bf16 v40, v128, v10, 0
    v_dot2_f32_bf16 v41, v128, v18, 0
    v_dot2_f32_bf16 v42, v132, v10, 0
    v_dot2_f32_bf16 v43, v132, v18, 0
    v_dot2_f32_bf16 v36, v121, v12, v36
    v_dot2_f32_bf16 v37, v121, v20, v37
    v_dot2_f32_bf16 v38, v125, v12, v38
    v_dot2_f32_bf16 v39, v125, v20, v39
    v_dot2_f32_bf16 v40, v129, v12, v40
    v_dot2_f32_bf16 v41, v129, v20, v41
    v_dot2_f32_bf16 v42, v133, v12, v42
    v_dot2_f32_bf16 v43, v133, v20, v43
    v_dot2_f32_bf16 v36, v122, v14, v36
    v_dot2_f32_bf16 v37, v122, v22, v37
    v_dot2_f32_bf16 v38, v126, v14, v38
    v_dot2_f32_bf16 v39, v126, v22, v39
    v_dot2_f32_bf16 v40, v130, v14, v40
    v_dot2_f32_bf16 v41, v130, v22, v41
    v_dot2_f32_bf16 v42, v134, v14, v42
    v_dot2_f32_bf16 v43, v134, v22, v43
    v_dot2_f32_bf16 v36, v123, v16, v36
    v_dot2_f32_bf16 v37, v123, v24, v37
    v_dot2_f32_bf16 v38, v127, v16, v38
    v_dot2_f32_bf16 v39, v127, v24, v39
    v_dot2_f32_bf16 v40, v131, v16, v40
    v_dot2_f32_bf16 v41, v131, v24, v41
    v_dot2_f32_bf16 v42, v135, v16, v42
    v_dot2_f32_bf16 v43, v135, v24, v43
    v_add_f32_dpp v44, v36, v36 row_ror:8 row_mask:0xf bank_mask:0x3
    v_add_f32_dpp v45, v38, v38 row_ror:8 row_mask:0xf bank_mask:0x3
    v_add_f32_dpp v46, v40, v40 row_ror:8 row_mask:0xf bank_mask:0x3
    v_add_f32_dpp v47, v42, v42 row_ror:8 row_mask:0xf bank_mask:0x3
    v_add_f32_dpp v44, v37, v37 row_ror:8 row_mask:0xf bank_mask:0xc
    v_add_f32_dpp v45, v39, v39 row_ror:8 row_mask:0xf bank_mask:0xc
    v_add_f32_dpp v46, v41, v41 row_ror:8 row_mask:0xf bank_mask:0xc
    v_add_f32_dpp v47, v43, v43 row_ror:8 row_mask:0xf bank_mask:0xc
    v_add_f32_dpp v44, v44, v44 row_half_mirror row_mask:0xf bank_mask:0xf
    v_add_f32_dpp v45, v45, v45 row_half_mirror row_mask:0xf bank_mask:0xf
    v_add_f32_dpp v46, v46, v46 row_half_mirror row_mask:0xf bank_mask:0xf
    v_add_f32_dpp v47, v47, v47 row_half_mirror row_mask:0xf bank_mask:0xf
    v_add_f32_dpp v44, v44, v44 quad_perm:[1,0,3,2] row_mask:0xf bank_mask:0xf
    v_add_f32_dpp v45, v45, v45 quad_perm:[1,0,3,2] row_mask:0xf bank_mask:0xf
    v_add_f32_dpp v46, v46, v46 quad_perm:[1,0,3,2] row_mask:0xf bank_mask:0xf
    v_add_f32_dpp v47, v47, v47 quad_perm:[1,0,3,2] row_mask:0xf bank_mask:0xf
    v_add_f32_dpp v44, v44, v44 quad_perm:[2,3,0,1] row_mask:0xf bank_mask:0xf
    v_add_f32_dpp v45, v45, v45 quad_perm:[2,3,0,1] row_mask:0xf bank_mask:0xf
    v_add_f32_dpp v46, v46, v46 quad_perm:[2,3,0,1] row_mask:0xf bank_mask:0xf
    v_add_f32_dpp v47, v47, v47 quad_perm:[2,3,0,1] row_mask:0xf bank_mask:0xf
    v_cvt_pk_bf16_f32 v48, v44, v45
    v_cvt_pk_bf16_f32 v50, v46, v47
    v_max3_f32 v26, v26, v44, v45
    v_and_b32 v49, 0xffff0000, v48
    v_lshlrev_b32 v48, 16, v48
    v_and_b32 v51, 0xffff0000, v50
    v_lshlrev_b32 v50, 16, v50
    v_max3_f32 v26, v26, v46, v47
    v_mul_f32 v48, 1035273459, v48
    v_mul_f32 v49, 1035273459, v49
    v_mul_f32 v50, 1035273459, v50
    v_mul_f32 v51, 1035273459, v51
    v_cvt_pk_bf16_f32 v68, v48, v49
    v_cvt_pk_bf16_f32 v69, v50, v51
    s_waitcnt vmcnt(3)
    buffer_load_dwordx4 v[204:207], v1, s[40:43], s51 offen offset:1024 nt
    v_dot2_f32_bf16 v36, v136, v10, 0
    v_dot2_f32_bf16 v37, v136, v18, 0
    v_dot2_f32_bf16 v38, v140, v10, 0
    v_dot2_f32_bf16 v39, v140, v18, 0
    v_dot2_f32_bf16 v40, v144, v10, 0
    v_dot2_f32_bf16 v41, v144, v18, 0
    v_dot2_f32_bf16 v42, v148, v10, 0
    v_dot2_f32_bf16 v43, v148, v18, 0
    v_dot2_f32_bf16 v36, v137, v12, v36
    v_dot2_f32_bf16 v37, v137, v20, v37
    v_dot2_f32_bf16 v38, v141, v12, v38
    v_dot2_f32_bf16 v39, v141, v20, v39
    v_dot2_f32_bf16 v40, v145, v12, v40
    v_dot2_f32_bf16 v41, v145, v20, v41
    v_dot2_f32_bf16 v42, v149, v12, v42
    v_dot2_f32_bf16 v43, v149, v20, v43
    v_dot2_f32_bf16 v36, v138, v14, v36
    v_dot2_f32_bf16 v37, v138, v22, v37
    v_dot2_f32_bf16 v38, v142, v14, v38
    v_dot2_f32_bf16 v39, v142, v22, v39
    v_dot2_f32_bf16 v40, v146, v14, v40
    v_dot2_f32_bf16 v41, v146, v22, v41
    v_dot2_f32_bf16 v42, v150, v14, v42
    v_dot2_f32_bf16 v43, v150, v22, v43
    v_dot2_f32_bf16 v36, v139, v16, v36
    v_dot2_f32_bf16 v37, v139, v24, v37
    v_dot2_f32_bf16 v38, v143, v16, v38
    v_dot2_f32_bf16 v39, v143, v24, v39
    v_dot2_f32_bf16 v40, v147, v16, v40
    v_dot2_f32_bf16 v41, v147, v24, v41
    v_dot2_f32_bf16 v42, v151, v16, v42
    v_dot2_f32_bf16 v43, v151, v24, v43
    v_add_f32_dpp v44, v36, v36 row_ror:8 row_mask:0xf bank_mask:0x3
    v_add_f32_dpp v45, v38, v38 row_ror:8 row_mask:0xf bank_mask:0x3
    v_add_f32_dpp v46, v40, v40 row_ror:8 row_mask:0xf bank_mask:0x3
    v_add_f32_dpp v47, v42, v42 row_ror:8 row_mask:0xf bank_mask:0x3
    v_add_f32_dpp v44, v37, v37 row_ror:8 row_mask:0xf bank_mask:0xc
    v_add_f32_dpp v45, v39, v39 row_ror:8 row_mask:0xf bank_mask:0xc
    v_add_f32_dpp v46, v41, v41 row_ror:8 row_mask:0xf bank_mask:0xc
    v_add_f32_dpp v47, v43, v43 row_ror:8 row_mask:0xf bank_mask:0xc
    v_add_f32_dpp v44, v44, v44 row_half_mirror row_mask:0xf bank_mask:0xf
    v_add_f32_dpp v45, v45, v45 row_half_mirror row_mask:0xf bank_mask:0xf
    v_add_f32_dpp v46, v46, v46 row_half_mirror row_mask:0xf bank_mask:0xf
    v_add_f32_dpp v47, v47, v47 row_half_mirror row_mask:0xf bank_mask:0xf
    v_add_f32_dpp v44, v44, v44 quad_perm:[1,0,3,2] row_mask:0xf bank_mask:0xf
    v_add_f32_dpp v45, v45, v45 quad_perm:[1,0,3,2] row_mask:0xf bank_mask:0xf
    v_add_f32_dpp v46, v46, v46 quad_perm:[1,0,3,2] row_mask:0xf bank_mask:0xf
    v_add_f32_dpp v47, v47, v47 quad_perm:[1,0,3,2] row_mask:0xf bank_mask:0xf
    v_add_f32_dpp v44, v44, v44 quad_perm:[2,3,0,1] row_mask:0xf bank_mask:0xf
    v_add_f32_dpp v45, v45, v45 quad_perm:[2,3,0,1] row_mask:0xf bank_mask:0xf
    v_add_f32_dpp v46, v46, v46 quad_perm:[2,3,0,1] row_mask:0xf bank_mask:0xf
    v_add_f32_dpp v47, v47, v47 quad_perm:[2,3,0,1] row_mask:0xf bank_mask:0xf
    v_cvt_pk_bf16_f32 v48, v44, v45
    v_cvt_pk_bf16_f32 v50, v46, v47
    v_max3_f32 v26, v26, v44, v45
    v_and_b32 v49, 0xffff0000, v48
    v_lshlrev_b32 v48, 16, v48
    v_and_b32 v51, 0xffff0000, v50
    v_lshlrev_b32 v50, 16, v50
    v_max3_f32 v26, v26, v46, v47
    v_mul_f32 v48, 1035273459, v48
    v_mul_f32 v49, 1035273459, v49
    v_mul_f32 v50, 1035273459, v50
    v_mul_f32 v51, 1035273459, v51
    v_cvt_pk_bf16_f32 v70, v48, v49
    v_cvt_pk_bf16_f32 v71, v50, v51
    s_waitcnt vmcnt(3)
    buffer_load_dwordx4 v[208:211], v1, s[40:43], s51 offen offset:2048 nt
    v_dot2_f32_bf16 v36, v152, v10, 0
    v_dot2_f32_bf16 v37, v152, v18, 0
    v_dot2_f32_bf16 v38, v156, v10, 0
    v_dot2_f32_bf16 v39, v156, v18, 0
    v_dot2_f32_bf16 v40, v160, v10, 0
    v_dot2_f32_bf16 v41, v160, v18, 0
    v_dot2_f32_bf16 v42, v164, v10, 0
    v_dot2_f32_bf16 v43, v164, v18, 0
    v_dot2_f32_bf16 v36, v153, v12, v36
    v_dot2_f32_bf16 v37, v153, v20, v37
    v_dot2_f32_bf16 v38, v157, v12, v38
    v_dot2_f32_bf16 v39, v157, v20, v39
    v_dot2_f32_bf16 v40, v161, v12, v40
    v_dot2_f32_bf16 v41, v161, v20, v41
    v_dot2_f32_bf16 v42, v165, v12, v42
    v_dot2_f32_bf16 v43, v165, v20, v43
    v_dot2_f32_bf16 v36, v154, v14, v36
    v_dot2_f32_bf16 v37, v154, v22, v37
    v_dot2_f32_bf16 v38, v158, v14, v38
    v_dot2_f32_bf16 v39, v158, v22, v39
    v_dot2_f32_bf16 v40, v162, v14, v40
    v_dot2_f32_bf16 v41, v162, v22, v41
    v_dot2_f32_bf16 v42, v166, v14, v42
    v_dot2_f32_bf16 v43, v166, v22, v43
    v_dot2_f32_bf16 v36, v155, v16, v36
    v_dot2_f32_bf16 v37, v155, v24, v37
    v_dot2_f32_bf16 v38, v159, v16, v38
    v_dot2_f32_bf16 v39, v159, v24, v39
    v_dot2_f32_bf16 v40, v163, v16, v40
    v_dot2_f32_bf16 v41, v163, v24, v41
    v_dot2_f32_bf16 v42, v167, v16, v42
    v_dot2_f32_bf16 v43, v167, v24, v43
    v_add_f32_dpp v44, v36, v36 row_ror:8 row_mask:0xf bank_mask:0x3
    v_add_f32_dpp v45, v38, v38 row_ror:8 row_mask:0xf bank_mask:0x3
    v_add_f32_dpp v46, v40, v40 row_ror:8 row_mask:0xf bank_mask:0x3
    v_add_f32_dpp v47, v42, v42 row_ror:8 row_mask:0xf bank_mask:0x3
    v_add_f32_dpp v44, v37, v37 row_ror:8 row_mask:0xf bank_mask:0xc
    v_add_f32_dpp v45, v39, v39 row_ror:8 row_mask:0xf bank_mask:0xc
    v_add_f32_dpp v46, v41, v41 row_ror:8 row_mask:0xf bank_mask:0xc
    v_add_f32_dpp v47, v43, v43 row_ror:8 row_mask:0xf bank_mask:0xc
    v_add_f32_dpp v44, v44, v44 row_half_mirror row_mask:0xf bank_mask:0xf
    v_add_f32_dpp v45, v45, v45 row_half_mirror row_mask:0xf bank_mask:0xf
    v_add_f32_dpp v46, v46, v46 row_half_mirror row_mask:0xf bank_mask:0xf
    v_add_f32_dpp v47, v47, v47 row_half_mirror row_mask:0xf bank_mask:0xf
    v_add_f32_dpp v44, v44, v44 quad_perm:[1,0,3,2] row_mask:0xf bank_mask:0xf
    v_add_f32_dpp v45, v45, v45 quad_perm:[1,0,3,2] row_mask:0xf bank_mask:0xf
    v_add_f32_dpp v46, v46, v46 quad_perm:[1,0,3,2] row_mask:0xf bank_mask:0xf
    v_add_f32_dpp v47, v47, v47 quad_perm:[1,0,3,2] row_mask:0xf bank_mask:0xf
    v_add_f32_dpp v44, v44, v44 quad_perm:[2,3,0,1] row_mask:0xf bank_mask:0xf
    v_add_f32_dpp v45, v45, v45 quad_perm:[2,3,0,1] row_mask:0xf bank_mask:0xf
    v_add_f32_dpp v46, v46, v46 quad_perm:[2,3,0,1] row_mask:0xf bank_mask:0xf
    v_add_f32_dpp v47, v47, v47 quad_perm:[2,3,0,1] row_mask:0xf bank_mask:0xf
    v_cvt_pk_bf16_f32 v48, v44, v45
    v_cvt_pk_bf16_f32 v50, v46, v47
    v_max3_f32 v26, v26, v44, v45
    v_and_b32 v49, 0xffff0000, v48
    v_lshlrev_b32 v48, 16, v48
    v_and_b32 v51, 0xffff0000, v50
    v_lshlrev_b32 v50, 16, v50
    v_max3_f32 v26, v26, v46, v47
    v_mul_f32 v48, 1035273459, v48
    v_mul_f32 v49, 1035273459, v49
    v_mul_f32 v50, 1035273459, v50
    v_mul_f32 v51, 1035273459, v51
    v_cvt_pk_bf16_f32 v72, v48, v49
    v_cvt_pk_bf16_f32 v73, v50, v51
    s_waitcnt vmcnt(3)
    buffer_load_dwordx4 v[212:215], v1, s[40:43], s51 offen offset:3072 nt
    v_dot2_f32_bf16 v36, v168, v10, 0
    v_dot2_f32_bf16 v37, v168, v18, 0
    v_dot2_f32_bf16 v38, v172, v10, 0
    v_dot2_f32_bf16 v39, v172, v18, 0
    v_dot2_f32_bf16 v40, v176, v10, 0
    v_dot2_f32_bf16 v41, v176, v18, 0
    v_dot2_f32_bf16 v42, v180, v10, 0
    v_dot2_f32_bf16 v43, v180, v18, 0
    v_dot2_f32_bf16 v36, v169, v12, v36
    v_dot2_f32_bf16 v37, v169, v20, v37
    v_dot2_f32_bf16 v38, v173, v12, v38
    v_dot2_f32_bf16 v39, v173, v20, v39
    v_dot2_f32_bf16 v40, v177, v12, v40
    v_dot2_f32_bf16 v41, v177, v20, v41
    v_dot2_f32_bf16 v42, v181, v12, v42
    v_dot2_f32_bf16 v43, v181, v20, v43
    v_dot2_f32_bf16 v36, v170, v14, v36
    v_dot2_f32_bf16 v37, v170, v22, v37
    v_dot2_f32_bf16 v38, v174, v14, v38
    v_dot2_f32_bf16 v39, v174, v22, v39
    v_dot2_f32_bf16 v40, v178, v14, v40
    v_dot2_f32_bf16 v41, v178, v22, v41
    v_dot2_f32_bf16 v42, v182, v14, v42
    v_dot2_f32_bf16 v43, v182, v22, v43
    v_dot2_f32_bf16 v36, v171, v16, v36
    v_dot2_f32_bf16 v37, v171, v24, v37
    v_dot2_f32_bf16 v38, v175, v16, v38
    v_dot2_f32_bf16 v39, v175, v24, v39
    v_dot2_f32_bf16 v40, v179, v16, v40
    v_dot2_f32_bf16 v41, v179, v24, v41
    v_dot2_f32_bf16 v42, v183, v16, v42
    v_dot2_f32_bf16 v43, v183, v24, v43
    v_add_f32_dpp v44, v36, v36 row_ror:8 row_mask:0xf bank_mask:0x3
    v_add_f32_dpp v45, v38, v38 row_ror:8 row_mask:0xf bank_mask:0x3
    v_add_f32_dpp v46, v40, v40 row_ror:8 row_mask:0xf bank_mask:0x3
    v_add_f32_dpp v47, v42, v42 row_ror:8 row_mask:0xf bank_mask:0x3
    v_add_f32_dpp v44, v37, v37 row_ror:8 row_mask:0xf bank_mask:0xc
    v_add_f32_dpp v45, v39, v39 row_ror:8 row_mask:0xf bank_mask:0xc
    v_add_f32_dpp v46, v41, v41 row_ror:8 row_mask:0xf bank_mask:0xc
    v_add_f32_dpp v47, v43, v43 row_ror:8 row_mask:0xf bank_mask:0xc
    v_add_f32_dpp v44, v44, v44 row_half_mirror row_mask:0xf bank_mask:0xf
    v_add_f32_dpp v45, v45, v45 row_half_mirror row_mask:0xf bank_mask:0xf
    v_add_f32_dpp v46, v46, v46 row_half_mirror row_mask:0xf bank_mask:0xf
    v_add_f32_dpp v47, v47, v47 row_half_mirror row_mask:0xf bank_mask:0xf
    v_add_f32_dpp v44, v44, v44 quad_perm:[1,0,3,2] row_mask:0xf bank_mask:0xf
    v_add_f32_dpp v45, v45, v45 quad_perm:[1,0,3,2] row_mask:0xf bank_mask:0xf
    v_add_f32_dpp v46, v46, v46 quad_perm:[1,0,3,2] row_mask:0xf bank_mask:0xf
    v_add_f32_dpp v47, v47, v47 quad_perm:[1,0,3,2] row_mask:0xf bank_mask:0xf
    v_add_f32_dpp v44, v44, v44 quad_perm:[2,3,0,1] row_mask:0xf bank_mask:0xf
    v_add_f32_dpp v45, v45, v45 quad_perm:[2,3,0,1] row_mask:0xf bank_mask:0xf
    v_add_f32_dpp v46, v46, v46 quad_perm:[2,3,0,1] row_mask:0xf bank_mask:0xf
    v_add_f32_dpp v47, v47, v47 quad_perm:[2,3,0,1] row_mask:0xf bank_mask:0xf
    v_cvt_pk_bf16_f32 v48, v44, v45
    v_cvt_pk_bf16_f32 v50, v46, v47
    v_max3_f32 v26, v26, v44, v45
    v_and_b32 v49, 0xffff0000, v48
    v_lshlrev_b32 v48, 16, v48
    v_and_b32 v51, 0xffff0000, v50
    v_lshlrev_b32 v50, 16, v50
    v_max3_f32 v26, v26, v46, v47
    v_mul_f32 v48, 1035273459, v48
    v_mul_f32 v49, 1035273459, v49
    v_mul_f32 v50, 1035273459, v50
    v_mul_f32 v51, 1035273459, v51
    v_cvt_pk_bf16_f32 v74, v48, v49
    v_cvt_pk_bf16_f32 v75, v50, v51
    s_waitcnt vmcnt(3)
    s_add_u32 s51, s60, 1572864
    s_and_b32 s51, s51, 0x1fffff
    buffer_load_dwordx4 v[216:219], v1, s[40:43], s51 offen offset:0 nt
    v_dot2_f32_bf16 v36, v184, v10, 0
    v_dot2_f32_bf16 v37, v184, v18, 0
    v_dot2_f32_bf16 v38, v188, v10, 0
    v_dot2_f32_bf16 v39, v188, v18, 0
    v_dot2_f32_bf16 v40, v192, v10, 0
    v_dot2_f32_bf16 v41, v192, v18, 0
    v_dot2_f32_bf16 v42, v196, v10, 0
    v_dot2_f32_bf16 v43, v196, v18, 0
    v_dot2_f32_bf16 v36, v185, v12, v36
    v_dot2_f32_bf16 v37, v185, v20, v37
    v_dot2_f32_bf16 v38, v189, v12, v38
    v_dot2_f32_bf16 v39, v189, v20, v39
    v_dot2_f32_bf16 v40, v193, v12, v40
    v_dot2_f32_bf16 v41, v193, v20, v41
    v_dot2_f32_bf16 v42, v197, v12, v42
    v_dot2_f32_bf16 v43, v197, v20, v43
    v_dot2_f32_bf16 v36, v186, v14, v36
    v_dot2_f32_bf16 v37, v186, v22, v37
    v_dot2_f32_bf16 v38, v190, v14, v38
    v_dot2_f32_bf16 v39, v190, v22, v39
    v_dot2_f32_bf16 v40, v194, v14, v40
    v_dot2_f32_bf16 v41, v194, v22, v41
    v_dot2_f32_bf16 v42, v198, v14, v42
    v_dot2_f32_bf16 v43, v198, v22, v43
    v_dot2_f32_bf16 v36, v187, v16, v36
    v_dot2_f32_bf16 v37, v187, v24, v37
    v_dot2_f32_bf16 v38, v191, v16, v38
    v_dot2_f32_bf16 v39, v191, v24, v39
    v_dot2_f32_bf16 v40, v195, v16, v40
    v_dot2_f32_bf16 v41, v195, v24, v41
    v_dot2_f32_bf16 v42, v199, v16, v42
    v_dot2_f32_bf16 v43, v199, v24, v43
    v_add_f32_dpp v44, v36, v36 row_ror:8 row_mask:0xf bank_mask:0x3
    v_add_f32_dpp v45, v38, v38 row_ror:8 row_mask:0xf bank_mask:0x3
    v_add_f32_dpp v46, v40, v40 row_ror:8 row_mask:0xf bank_mask:0x3
    v_add_f32_dpp v47, v42, v42 row_ror:8 row_mask:0xf bank_mask:0x3
    v_add_f32_dpp v44, v37, v37 row_ror:8 row_mask:0xf bank_mask:0xc
    v_add_f32_dpp v45, v39, v39 row_ror:8 row_mask:0xf bank_mask:0xc
    v_add_f32_dpp v46, v41, v41 row_ror:8 row_mask:0xf bank_mask:0xc
    v_add_f32_dpp v47, v43, v43 row_ror:8 row_mask:0xf bank_mask:0xc
    v_add_f32_dpp v44, v44, v44 row_half_mirror row_mask:0xf bank_mask:0xf
    v_add_f32_dpp v45, v45, v45 row_half_mirror row_mask:0xf bank_mask:0xf
    v_add_f32_dpp v46, v46, v46 row_half_mirror row_mask:0xf bank_mask:0xf
    v_add_f32_dpp v47, v47, v47 row_half_mirror row_mask:0xf bank_mask:0xf
    v_add_f32_dpp v44, v44, v44 quad_perm:[1,0,3,2] row_mask:0xf bank_mask:0xf
    v_add_f32_dpp v45, v45, v45 quad_perm:[1,0,3,2] row_mask:0xf bank_mask:0xf
    v_add_f32_dpp v46, v46, v46 quad_perm:[1,0,3,2] row_mask:0xf bank_mask:0xf
    v_add_f32_dpp v47, v47, v47 quad_perm:[1,0,3,2] row_mask:0xf bank_mask:0xf
    v_add_f32_dpp v44, v44, v44 quad_perm:[2,3,0,1] row_mask:0xf bank_mask:0xf
    v_add_f32_dpp v45, v45, v45 quad_perm:[2,3,0,1] row_mask:0xf bank_mask:0xf
    v_add_f32_dpp v46, v46, v46 quad_perm:[2,3,0,1] row_mask:0xf bank_mask:0xf
    v_add_f32_dpp v47, v47, v47 quad_perm:[2,3,0,1] row_mask:0xf bank_mask:0xf
    v_cvt_pk_bf16_f32 v48, v44, v45
    v_cvt_pk_bf16_f32 v50, v46, v47
    v_max3_f32 v26, v26, v44, v45
    v_and_b32 v49, 0xffff0000, v48
    v_lshlrev_b32 v48, 16, v48
    v_and_b32 v51, 0xffff0000, v50
    v_lshlrev_b32 v50, 16, v50
    v_max3_f32 v26, v26, v46, v47
    v_mul_f32 v48, 1035273459, v48
    v_mul_f32 v49, 1035273459, v49
    v_mul_f32 v50, 1035273459, v50
    v_mul_f32 v51, 1035273459, v51
    v_cvt_pk_bf16_f32 v76, v48, v49
    v_cvt_pk_bf16_f32 v77, v50, v51
    s_waitcnt vmcnt(3)
    buffer_load_dwordx4 v[220:223], v1, s[40:43], s51 offen offset:1024 nt
    s_waitcnt vmcnt(3)
    buffer_load_dwordx4 v[224:227], v1, s[40:43], s51 offen offset:2048 nt
    s_waitcnt vmcnt(3)
    buffer_load_dwordx4 v[228:231], v1, s[40:43], s51 offen offset:3072 nt
    v_dot2_f32_bf16 v36, v200, v10, 0
    v_dot2_f32_bf16 v37, v200, v18, 0
    v_dot2_f32_bf16 v38, v204, v10, 0
    v_dot2_f32_bf16 v39, v204, v18, 0
    v_dot2_f32_bf16 v40, v208, v10, 0
    v_dot2_f32_bf16 v41, v208, v18, 0
    v_dot2_f32_bf16 v42, v212, v10, 0
    v_dot2_f32_bf16 v43, v212, v18, 0
    v_dot2_f32_bf16 v36, v201, v12, v36
    v_dot2_f32_bf16 v37, v201, v20, v37
    v_dot2_f32_bf16 v38, v205, v12, v38
    v_dot2_f32_bf16 v39, v205, v20, v39
    v_dot2_f32_bf16 v40, v209, v12, v40
    v_dot2_f32_bf16 v41, v209, v20, v41
    v_dot2_f32_bf16 v42, v213, v12, v42
    v_dot2_f32_bf16 v43, v213, v20, v43
    v_dot2_f32_bf16 v36, v202, v14, v36
    v_dot2_f32_bf16 v37, v202, v22, v37
    v_dot2_f32_bf16 v38, v206, v14, v38
    v_dot2_f32_bf16 v39, v206, v22, v39
    v_dot2_f32_bf16 v40, v210, v14, v40
    v_dot2_f32_bf16 v41, v210, v22, v41
    v_dot2_f32_bf16 v42, v214, v14, v42
    v_dot2_f32_bf16 v43, v214, v22, v43
    v_dot2_f32_bf16 v36, v203, v16, v36
    v_dot2_f32_bf16 v37, v203, v24, v37
    v_dot2_f32_bf16 v38, v207, v16, v38
    v_dot2_f32_bf16 v39, v207, v24, v39
    v_dot2_f32_bf16 v40, v211, v16, v40
    v_dot2_f32_bf16 v41, v211, v24, v41
    v_dot2_f32_bf16 v42, v215, v16, v42
    v_dot2_f32_bf16 v43, v215, v24, v43
    v_add_f32_dpp v44, v36, v36 row_ror:8 row_mask:0xf bank_mask:0x3
    v_add_f32_dpp v45, v38, v38 row_ror:8 row_mask:0xf bank_mask:0x3
    v_add_f32_dpp v46, v40, v40 row_ror:8 row_mask:0xf bank_mask:0x3
    v_add_f32_dpp v47, v42, v42 row_ror:8 row_mask:0xf bank_mask:0x3
    v_add_f32_dpp v44, v37, v37 row_ror:8 row_mask:0xf bank_mask:0xc
    v_add_f32_dpp v45, v39, v39 row_ror:8 row_mask:0xf bank_mask:0xc
    v_add_f32_dpp v46, v41, v41 row_ror:8 row_mask:0xf bank_mask:0xc
    v_add_f32_dpp v47, v43, v43 row_ror:8 row_mask:0xf bank_mask:0xc
    v_add_f32_dpp v44, v44, v44 row_half_mirror row_mask:0xf bank_mask:0xf
    v_add_f32_dpp v45, v45, v45 row_half_mirror row_mask:0xf bank_mask:0xf
    v_add_f32_dpp v46, v46, v46 row_half_mirror row_mask:0xf bank_mask:0xf
    v_add_f32_dpp v47, v47, v47 row_half_mirror row_mask:0xf bank_mask:0xf
    v_add_f32_dpp v44, v44, v44 quad_perm:[1,0,3,2] row_mask:0xf bank_mask:0xf
    v_add_f32_dpp v45, v45, v45 quad_perm:[1,0,3,2] row_mask:0xf bank_mask:0xf
    v_add_f32_dpp v46, v46, v46 quad_perm:[1,0,3,2] row_mask:0xf bank_mask:0xf
    v_add_f32_dpp v47, v47, v47 quad_perm:[1,0,3,2] row_mask:0xf bank_mask:0xf
    v_add_f32_dpp v44, v44, v44 quad_perm:[2,3,0,1] row_mask:0xf bank_mask:0xf
    v_add_f32_dpp v45, v45, v45 quad_perm:[2,3,0,1] row_mask:0xf bank_mask:0xf
    v_add_f32_dpp v46, v46, v46 quad_perm:[2,3,0,1] row_mask:0xf bank_mask:0xf
    v_add_f32_dpp v47, v47, v47 quad_perm:[2,3,0,1] row_mask:0xf bank_mask:0xf
    v_cvt_pk_bf16_f32 v48, v44, v45
    v_cvt_pk_bf16_f32 v50, v46, v47
    v_max3_f32 v26, v26, v44, v45
    v_and_b32 v49, 0xffff0000, v48
    v_lshlrev_b32 v48, 16, v48
    v_and_b32 v51, 0xffff0000, v50
    v_lshlrev_b32 v50, 16, v50
    v_max3_f32 v26, v26, v46, v47
    v_mul_f32 v48, 1035273459, v48
    v_mul_f32 v49, 1035273459, v49
    v_mul_f32 v50, 1035273459, v50
    v_mul_f32 v51, 1035273459, v51
    v_cvt_pk_bf16_f32 v78, v48, v49
    v_cvt_pk_bf16_f32 v79, v50, v51
    s_waitcnt vmcnt(3)
    s_add_u32 s51, s60, 0
    s_and_b32 s51, s51, 0x1fffff
    buffer_load_dwordx4 v[232:235], v1, s[44:47], s51 offen offset:0 nt
    s_waitcnt vmcnt(3)
    buffer_load_dwordx4 v[236:239], v1, s[44:47], s51 offen offset:1024 nt
    s_waitcnt vmcnt(3)
    buffer_load_dwordx4 v[240:243], v1, s[44:47], s51 offen offset:2048 nt
    s_waitcnt vmcnt(3)
    buffer_load_dwordx4 v[244:247], v1, s[44:47], s51 offen offset:3072 nt
    v_dot2_f32_bf16 v36, v216, v10, 0
    v_dot2_f32_bf16 v37, v216, v18, 0
    v_dot2_f32_bf16 v38, v220, v10, 0
    v_dot2_f32_bf16 v39, v220, v18, 0
    v_dot2_f32_bf16 v40, v224, v10, 0
    v_dot2_f32_bf16 v41, v224, v18, 0
    v_dot2_f32_bf16 v42, v228, v10, 0
    v_dot2_f32_bf16 v43, v228, v18, 0
    v_dot2_f32_bf16 v36, v217, v12, v36
    v_dot2_f32_bf16 v37, v217, v20, v37
    v_dot2_f32_bf16 v38, v221, v12, v38
    v_dot2_f32_bf16 v39, v221, v20, v39
    v_dot2_f32_bf16 v40, v225, v12, v40
    v_dot2_f32_bf16 v41, v225, v20, v41
    v_dot2_f32_bf16 v42, v229, v12, v42
    v_dot2_f32_bf16 v43, v229, v20, v43
    v_dot2_f32_bf16 v36, v218, v14, v36
    v_dot2_f32_bf16 v37, v218, v22, v37
    v_dot2_f32_bf16 v38, v222, v14, v38
    v_dot2_f32_bf16 v39, v222, v22, v39
    v_dot2_f32_bf16 v40, v226, v14, v40
    v_dot2_f32_bf16 v41, v226, v22, v41
    v_dot2_f32_bf16 v42, v230, v14, v42
    v_dot2_f32_bf16 v43, v230, v22, v43
    v_dot2_f32_bf16 v36, v219, v16, v36
    v_dot2_f32_bf16 v37, v219, v24, v37
    v_dot2_f32_bf16 v38, v223, v16, v38
    v_dot2_f32_bf16 v39, v223, v24, v39
    v_dot2_f32_bf16 v40, v227, v16, v40
    v_dot2_f32_bf16 v41, v227, v24, v41
    v_dot2_f32_bf16 v42, v231, v16, v42
    v_dot2_f32_bf16 v43, v231, v24, v43
    v_add_f32_dpp v44, v36, v36 row_ror:8 row_mask:0xf bank_mask:0x3
    v_add_f32_dpp v45, v38, v38 row_ror:8 row_mask:0xf bank_mask:0x3
    v_add_f32_dpp v46, v40, v40 row_ror:8 row_mask:0xf bank_mask:0x3
    v_add_f32_dpp v47, v42, v42 row_ror:8 row_mask:0xf bank_mask:0x3
    v_add_f32_dpp v44, v37, v37 row_ror:8 row_mask:0xf bank_mask:0xc
    v_add_f32_dpp v45, v39, v39 row_ror:8 row_mask:0xf bank_mask:0xc
    v_add_f32_dpp v46, v41, v41 row_ror:8 row_mask:0xf bank_mask:0xc
    v_add_f32_dpp v47, v43, v43 row_ror:8 row_mask:0xf bank_mask:0xc
    v_add_f32_dpp v44, v44, v44 row_half_mirror row_mask:0xf bank_mask:0xf
    v_add_f32_dpp v45, v45, v45 row_half_mirror row_mask:0xf bank_mask:0xf
    v_add_f32_dpp v46, v46, v46 row_half_mirror row_mask:0xf bank_mask:0xf
    v_add_f32_dpp v47, v47, v47 row_half_mirror row_mask:0xf bank_mask:0xf
    v_add_f32_dpp v44, v44, v44 quad_perm:[1,0,3,2] row_mask:0xf bank_mask:0xf
    v_add_f32_dpp v45, v45, v45 quad_perm:[1,0,3,2] row_mask:0xf bank_mask:0xf
    v_add_f32_dpp v46, v46, v46 quad_perm:[1,0,3,2] row_mask:0xf bank_mask:0xf
    v_add_f32_dpp v47, v47, v47 quad_perm:[1,0,3,2] row_mask:0xf bank_mask:0xf
    v_add_f32_dpp v44, v44, v44 quad_perm:[2,3,0,1] row_mask:0xf bank_mask:0xf
    v_add_f32_dpp v45, v45, v45 quad_perm:[2,3,0,1] row_mask:0xf bank_mask:0xf
    v_add_f32_dpp v46, v46, v46 quad_perm:[2,3,0,1] row_mask:0xf bank_mask:0xf
    v_add_f32_dpp v47, v47, v47 quad_perm:[2,3,0,1] row_mask:0xf bank_mask:0xf
    v_cvt_pk_bf16_f32 v48, v44, v45
    v_cvt_pk_bf16_f32 v50, v46, v47
    v_max3_f32 v26, v26, v44, v45
    v_and_b32 v49, 0xffff0000, v48
    v_lshlrev_b32 v48, 16, v48
    v_and_b32 v51, 0xffff0000, v50
    v_lshlrev_b32 v50, 16, v50
    v_max3_f32 v26, v26, v46, v47
    v_mul_f32 v48, 1035273459, v48
    v_mul_f32 v49, 1035273459, v49
    v_mul_f32 v50, 1035273459, v50
    v_mul_f32 v51, 1035273459, v51
    v_cvt_pk_bf16_f32 v80, v48, v49
    v_cvt_pk_bf16_f32 v81, v50, v51
    v_mov_b32 v48, v26
    s_nop 1
    v_permlane16_swap_b32 v26, v48
    v_max_f32 v26, v26, v48
    v_mov_b32 v48, v26
    s_nop 1
    v_permlane32_swap_b32 v26, v48
    v_max_f32 v26, v26, v48
    v_cvt_pk_bf16_f32 v48, v26, v26
    v_and_b32 v48, 0xffff0000, v48
    v_mul_f32 v48, 1035273459, v48
    v_cvt_pk_bf16_f32 v48, v48, v48
    v_and_b32 v26, 0xffff0000, v48
    v_mul_f32 v26, 1069066811, v26
    s_waitcnt vmcnt(3)
    s_add_u32 s51, s60, 196608
    s_and_b32 s51, s51, 0x1fffff
    buffer_load_dwordx4 v[88:91], v1, s[44:47], s51 offen offset:0 nt
    s_waitcnt vmcnt(3)
    buffer_load_dwordx4 v[92:95], v1, s[44:47], s51 offen offset:1024 nt
    v_lshlrev_b32 v60, 16, v64
    v_and_b32 v61, 0xffff0000, v64
    v_fma_f32 v60, v60, s58, -v26
    v_fma_f32 v61, v61, s58, -v26
    v_exp_f32 v60, v60
    v_exp_f32 v61, v61
    v_add_f32 v27, v27, v60
    v_cvt_pk_bf16_f32 v62, v60, v61
    v_add_f32 v27, v27, v61
    v_perm_b32 v52, v62, v62, v2
    v_perm_b32 v53, v62, v62, v3
    v_perm_b32 v54, v62, v62, v4
    v_perm_b32 v55, v62, v62, v5
    v_perm_b32 v56, v62, v62, v6
    v_perm_b32 v57, v62, v62, v7
    v_perm_b32 v58, v62, v62, v8
    v_perm_b32 v59, v62, v62, v9
    v_mfma_f32_16x16x32_bf16 v[32:35], v[232:235], v[52:55], v[32:35]
    s_nop 0
    v_mfma_f32_16x16x32_bf16 v[32:35], v[236:239], v[56:59], v[32:35]
    s_waitcnt vmcnt(3)
    buffer_load_dwordx4 v[96:99], v1, s[44:47], s51 offen offset:2048 nt
    s_waitcnt vmcnt(3)
    buffer_load_dwordx4 v[100:103], v1, s[44:47], s51 offen offset:3072 nt
    v_lshlrev_b32 v60, 16, v65
    v_and_b32 v61, 0xffff0000, v65
    v_fma_f32 v60, v60, s58, -v26
    v_fma_f32 v61, v61, s58, -v26
    v_exp_f32 v60, v60
    v_exp_f32 v61, v61
    v_add_f32 v27, v27, v60
    v_cvt_pk_bf16_f32 v62, v60, v61
    v_add_f32 v27, v27, v61
    v_perm_b32 v52, v62, v62, v2
    v_perm_b32 v53, v62, v62, v3
    v_perm_b32 v54, v62, v62, v4
    v_perm_b32 v55, v62, v62, v5
    v_perm_b32 v56, v62, v62, v6
    v_perm_b32 v57, v62, v62, v7
    v_perm_b32 v58, v62, v62, v8
    v_perm_b32 v59, v62, v62, v9
    v_mfma_f32_16x16x32_bf16 v[32:35], v[240:243], v[52:55], v[32:35]
    s_nop 0
    v_mfma_f32_16x16x32_bf16 v[32:35], v[244:247], v[56:59], v[32:35]
    s_waitcnt vmcnt(3)
    s_add_u32 s51, s60, 393216
    s_and_b32 s51, s51, 0x1fffff
    buffer_load_dwordx4 v[104:107], v1, s[44:47], s51 offen offset:0 nt
    s_waitcnt vmcnt(3)
    buffer_load_dwordx4 v[108:111], v1, s[44:47], s51 offen offset:1024 nt
    v_lshlrev_b32 v60, 16, v66
    v_and_b32 v61, 0xffff0000, v66
    v_fma_f32 v60, v60, s58, -v26
    v_fma_f32 v61, v61, s58, -v26
    v_exp_f32 v60, v60
    v_exp_f32 v61, v61
    v_add_f32 v27, v27, v60
    v_cvt_pk_bf16_f32 v62, v60, v61
    v_add_f32 v27, v27, v61
    v_perm_b32 v52, v62, v62, v2
    v_perm_b32 v53, v62, v62, v3
    v_perm_b32 v54, v62, v62, v4
    v_perm_b32 v55, v62, v62, v5
    v_perm_b32 v56, v62, v62, v6
    v_perm_b32 v57, v62, v62, v7
    v_perm_b32 v58, v62, v62, v8
    v_perm_b32 v59, v62, v62, v9
    v_mfma_f32_16x16x32_bf16 v[32:35], v[88:91], v[52:55], v[32:35]
    s_nop 0
    v_mfma_f32_16x16x32_bf16 v[32:35], v[92:95], v[56:59], v[32:35]
    s_waitcnt vmcnt(3)
    buffer_load_dwordx4 v[112:115], v1, s[44:47], s51 offen offset:2048 nt
    s_waitcnt vmcnt(3)
    buffer_load_dwordx4 v[116:119], v1, s[44:47], s51 offen offset:3072 nt
    v_lshlrev_b32 v60, 16, v67
    v_and_b32 v61, 0xffff0000, v67
    v_fma_f32 v60, v60, s58, -v26
    v_fma_f32 v61, v61, s58, -v26
    v_exp_f32 v60, v60
    v_exp_f32 v61, v61
    v_add_f32 v27, v27, v60
    v_cvt_pk_bf16_f32 v62, v60, v61
    v_add_f32 v27, v27, v61
    v_perm_b32 v52, v62, v62, v2
    v_perm_b32 v53, v62, v62, v3
    v_perm_b32 v54, v62, v62, v4
    v_perm_b32 v55, v62, v62, v5
    v_perm_b32 v56, v62, v62, v6
    v_perm_b32 v57, v62, v62, v7
    v_perm_b32 v58, v62, v62, v8
    v_perm_b32 v59, v62, v62, v9
    v_mfma_f32_16x16x32_bf16 v[32:35], v[96:99], v[52:55], v[32:35]
    s_nop 0
    v_mfma_f32_16x16x32_bf16 v[32:35], v[100:103], v[56:59], v[32:35]
    s_waitcnt vmcnt(3)
    s_add_u32 s51, s60, 589824
    s_and_b32 s51, s51, 0x1fffff
    buffer_load_dwordx4 v[120:123], v1, s[44:47], s51 offen offset:0 nt
    s_waitcnt vmcnt(3)
    buffer_load_dwordx4 v[124:127], v1, s[44:47], s51 offen offset:1024 nt
    v_lshlrev_b32 v60, 16, v68
    v_and_b32 v61, 0xffff0000, v68
    v_fma_f32 v60, v60, s58, -v26
    v_fma_f32 v61, v61, s58, -v26
    v_exp_f32 v60, v60
    v_exp_f32 v61, v61
    v_add_f32 v27, v27, v60
    v_cvt_pk_bf16_f32 v62, v60, v61
    v_add_f32 v27, v27, v61
    v_perm_b32 v52, v62, v62, v2
    v_perm_b32 v53, v62, v62, v3
    v_perm_b32 v54, v62, v62, v4
    v_perm_b32 v55, v62, v62, v5
    v_perm_b32 v56, v62, v62, v6
    v_perm_b32 v57, v62, v62, v7
    v_perm_b32 v58, v62, v62, v8
    v_perm_b32 v59, v62, v62, v9
    v_mfma_f32_16x16x32_bf16 v[32:35], v[104:107], v[52:55], v[32:35]
    s_nop 0
    v_mfma_f32_16x16x32_bf16 v[32:35], v[108:111], v[56:59], v[32:35]
    s_waitcnt vmcnt(3)
    buffer_load_dwordx4 v[128:131], v1, s[44:47], s51 offen offset:2048 nt
    s_waitcnt vmcnt(3)
    buffer_load_dwordx4 v[132:135], v1, s[44:47], s51 offen offset:3072 nt
    v_lshlrev_b32 v60, 16, v69
    v_and_b32 v61, 0xffff0000, v69
    v_fma_f32 v60, v60, s58, -v26
    v_fma_f32 v61, v61, s58, -v26
    v_exp_f32 v60, v60
    v_exp_f32 v61, v61
    v_add_f32 v27, v27, v60
    v_cvt_pk_bf16_f32 v62, v60, v61
    v_add_f32 v27, v27, v61
    v_perm_b32 v52, v62, v62, v2
    v_perm_b32 v53, v62, v62, v3
    v_perm_b32 v54, v62, v62, v4
    v_perm_b32 v55, v62, v62, v5
    v_perm_b32 v56, v62, v62, v6
    v_perm_b32 v57, v62, v62, v7
    v_perm_b32 v58, v62, v62, v8
    v_perm_b32 v59, v62, v62, v9
    v_mfma_f32_16x16x32_bf16 v[32:35], v[112:115], v[52:55], v[32:35]
    s_nop 0
    v_mfma_f32_16x16x32_bf16 v[32:35], v[116:119], v[56:59], v[32:35]
    s_waitcnt vmcnt(3)
    s_add_u32 s51, s60, 786432
    s_and_b32 s51, s51, 0x1fffff
    buffer_load_dwordx4 v[136:139], v1, s[44:47], s51 offen offset:0 nt
    s_waitcnt vmcnt(3)
    buffer_load_dwordx4 v[140:143], v1, s[44:47], s51 offen offset:1024 nt
    v_lshlrev_b32 v60, 16, v70
    v_and_b32 v61, 0xffff0000, v70
    v_fma_f32 v60, v60, s58, -v26
    v_fma_f32 v61, v61, s58, -v26
    v_exp_f32 v60, v60
    v_exp_f32 v61, v61
    v_add_f32 v27, v27, v60
    v_cvt_pk_bf16_f32 v62, v60, v61
    v_add_f32 v27, v27, v61
    v_perm_b32 v52, v62, v62, v2
    v_perm_b32 v53, v62, v62, v3
    v_perm_b32 v54, v62, v62, v4
    v_perm_b32 v55, v62, v62, v5
    v_perm_b32 v56, v62, v62, v6
    v_perm_b32 v57, v62, v62, v7
    v_perm_b32 v58, v62, v62, v8
    v_perm_b32 v59, v62, v62, v9
    v_mfma_f32_16x16x32_bf16 v[32:35], v[120:123], v[52:55], v[32:35]
    s_nop 0
    v_mfma_f32_16x16x32_bf16 v[32:35], v[124:127], v[56:59], v[32:35]
    s_waitcnt vmcnt(3)
    buffer_load_dwordx4 v[144:147], v1, s[44:47], s51 offen offset:2048 nt
    s_waitcnt vmcnt(3)
    buffer_load_dwordx4 v[148:151], v1, s[44:47], s51 offen offset:3072 nt
    v_lshlrev_b32 v60, 16, v71
    v_and_b32 v61, 0xffff0000, v71
    v_fma_f32 v60, v60, s58, -v26
    v_fma_f32 v61, v61, s58, -v26
    v_exp_f32 v60, v60
    v_exp_f32 v61, v61
    v_add_f32 v27, v27, v60
    v_cvt_pk_bf16_f32 v62, v60, v61
    v_add_f32 v27, v27, v61
    v_perm_b32 v52, v62, v62, v2
    v_perm_b32 v53, v62, v62, v3
    v_perm_b32 v54, v62, v62, v4
    v_perm_b32 v55, v62, v62, v5
    v_perm_b32 v56, v62, v62, v6
    v_perm_b32 v57, v62, v62, v7
    v_perm_b32 v58, v62, v62, v8
    v_perm_b32 v59, v62, v62, v9
    v_mfma_f32_16x16x32_bf16 v[32:35], v[128:131], v[52:55], v[32:35]
    s_nop 0
    v_mfma_f32_16x16x32_bf16 v[32:35], v[132:135], v[56:59], v[32:35]
    s_waitcnt vmcnt(3)
    s_add_u32 s51, s60, 983040
    s_and_b32 s51, s51, 0x1fffff
    buffer_load_dwordx4 v[152:155], v1, s[44:47], s51 offen offset:0 nt
    s_waitcnt vmcnt(3)
    buffer_load_dwordx4 v[156:159], v1, s[44:47], s51 offen offset:1024 nt
    v_lshlrev_b32 v60, 16, v72
    v_and_b32 v61, 0xffff0000, v72
    v_fma_f32 v60, v60, s58, -v26
    v_fma_f32 v61, v61, s58, -v26
    v_exp_f32 v60, v60
    v_exp_f32 v61, v61
    v_add_f32 v27, v27, v60
    v_cvt_pk_bf16_f32 v62, v60, v61
    v_add_f32 v27, v27, v61
    v_perm_b32 v52, v62, v62, v2
    v_perm_b32 v53, v62, v62, v3
    v_perm_b32 v54, v62, v62, v4
    v_perm_b32 v55, v62, v62, v5
    v_perm_b32 v56, v62, v62, v6
    v_perm_b32 v57, v62, v62, v7
    v_perm_b32 v58, v62, v62, v8
    v_perm_b32 v59, v62, v62, v9
    v_mfma_f32_16x16x32_bf16 v[32:35], v[136:139], v[52:55], v[32:35]
    s_nop 0
    v_mfma_f32_16x16x32_bf16 v[32:35], v[140:143], v[56:59], v[32:35]
    s_waitcnt vmcnt(3)
    buffer_load_dwordx4 v[160:163], v1, s[44:47], s51 offen offset:2048 nt
    s_waitcnt vmcnt(3)
    buffer_load_dwordx4 v[164:167], v1, s[44:47], s51 offen offset:3072 nt
    v_lshlrev_b32 v60, 16, v73
    v_and_b32 v61, 0xffff0000, v73
    v_fma_f32 v60, v60, s58, -v26
    v_fma_f32 v61, v61, s58, -v26
    v_exp_f32 v60, v60
    v_exp_f32 v61, v61
    v_add_f32 v27, v27, v60
    v_cvt_pk_bf16_f32 v62, v60, v61
    v_add_f32 v27, v27, v61
    v_perm_b32 v52, v62, v62, v2
    v_perm_b32 v53, v62, v62, v3
    v_perm_b32 v54, v62, v62, v4
    v_perm_b32 v55, v62, v62, v5
    v_perm_b32 v56, v62, v62, v6
    v_perm_b32 v57, v62, v62, v7
    v_perm_b32 v58, v62, v62, v8
    v_perm_b32 v59, v62, v62, v9
    v_mfma_f32_16x16x32_bf16 v[32:35], v[144:147], v[52:55], v[32:35]
    s_nop 0
    v_mfma_f32_16x16x32_bf16 v[32:35], v[148:151], v[56:59], v[32:35]
    s_waitcnt vmcnt(3)
    s_add_u32 s51, s60, 1179648
    s_and_b32 s51, s51, 0x1fffff
    buffer_load_dwordx4 v[168:171], v1, s[44:47], s51 offen offset:0 nt
    s_waitcnt vmcnt(3)
    buffer_load_dwordx4 v[172:175], v1, s[44:47], s51 offen offset:1024 nt
    v_lshlrev_b32 v60, 16, v74
    v_and_b32 v61, 0xffff0000, v74
    v_fma_f32 v60, v60, s58, -v26
    v_fma_f32 v61, v61, s58, -v26
    v_exp_f32 v60, v60
    v_exp_f32 v61, v61
    v_add_f32 v27, v27, v60
    v_cvt_pk_bf16_f32 v62, v60, v61
    v_add_f32 v27, v27, v61
    v_perm_b32 v52, v62, v62, v2
    v_perm_b32 v53, v62, v62, v3
    v_perm_b32 v54, v62, v62, v4
    v_perm_b32 v55, v62, v62, v5
    v_perm_b32 v56, v62, v62, v6
    v_perm_b32 v57, v62, v62, v7
    v_perm_b32 v58, v62, v62, v8
    v_perm_b32 v59, v62, v62, v9
    v_mfma_f32_16x16x32_bf16 v[32:35], v[152:155], v[52:55], v[32:35]
    s_nop 0
    v_mfma_f32_16x16x32_bf16 v[32:35], v[156:159], v[56:59], v[32:35]
    s_waitcnt vmcnt(3)
    buffer_load_dwordx4 v[176:179], v1, s[44:47], s51 offen offset:2048 nt
    s_waitcnt vmcnt(3)
    buffer_load_dwordx4 v[180:183], v1, s[44:47], s51 offen offset:3072 nt
    v_lshlrev_b32 v60, 16, v75
    v_and_b32 v61, 0xffff0000, v75
    v_fma_f32 v60, v60, s58, -v26
    v_fma_f32 v61, v61, s58, -v26
    v_exp_f32 v60, v60
    v_exp_f32 v61, v61
    v_add_f32 v27, v27, v60
    v_cvt_pk_bf16_f32 v62, v60, v61
    v_add_f32 v27, v27, v61
    v_perm_b32 v52, v62, v62, v2
    v_perm_b32 v53, v62, v62, v3
    v_perm_b32 v54, v62, v62, v4
    v_perm_b32 v55, v62, v62, v5
    v_perm_b32 v56, v62, v62, v6
    v_perm_b32 v57, v62, v62, v7
    v_perm_b32 v58, v62, v62, v8
    v_perm_b32 v59, v62, v62, v9
    v_mfma_f32_16x16x32_bf16 v[32:35], v[160:163], v[52:55], v[32:35]
    s_nop 0
    v_mfma_f32_16x16x32_bf16 v[32:35], v[164:167], v[56:59], v[32:35]
    s_waitcnt vmcnt(3)
    s_add_u32 s51, s60, 1376256
    s_and_b32 s51, s51, 0x1fffff
    buffer_load_dwordx4 v[184:187], v1, s[44:47], s51 offen offset:0 nt
    s_waitcnt vmcnt(3)
    buffer_load_dwordx4 v[188:191], v1, s[44:47], s51 offen offset:1024 nt
    v_lshlrev_b32 v60, 16, v76
    v_and_b32 v61, 0xffff0000, v76
    v_fma_f32 v60, v60, s58, -v26
    v_fma_f32 v61, v61, s58, -v26
    v_exp_f32 v60, v60
    v_exp_f32 v61, v61
    v_add_f32 v27, v27, v60
    v_cvt_pk_bf16_f32 v62, v60, v61
    v_add_f32 v27, v27, v61
    v_perm_b32 v52, v62, v62, v2
    v_perm_b32 v53, v62, v62, v3
    v_perm_b32 v54, v62, v62, v4
    v_perm_b32 v55, v62, v62, v5
    v_perm_b32 v56, v62, v62, v6
    v_perm_b32 v57, v62, v62, v7
    v_perm_b32 v58, v62, v62, v8
    v_perm_b32 v59, v62, v62, v9
    v_mfma_f32_16x16x32_bf16 v[32:35], v[168:171], v[52:55], v[32:35]
    s_nop 0
    v_mfma_f32_16x16x32_bf16 v[32:35], v[172:175], v[56:59], v[32:35]
    s_waitcnt vmcnt(3)
    buffer_load_dwordx4 v[192:195], v1, s[44:47], s51 offen offset:2048 nt
    s_waitcnt vmcnt(3)
    v_mov_b32 v86, 1
    s_mov_b64 exec, 1
    buffer_atomic_add v86, v85, s[36:39], s62 offen sc0
    s_mov_b64 exec, -1
    buffer_load_dwordx4 v[196:199], v1, s[44:47], s51 offen offset:3072 nt
    v_lshlrev_b32 v60, 16, v77
    v_and_b32 v61, 0xffff0000, v77
    v_fma_f32 v60, v60, s58, -v26
    v_fma_f32 v61, v61, s58, -v26
    v_exp_f32 v60, v60
    v_exp_f32 v61, v61
    v_add_f32 v27, v27, v60
    v_cvt_pk_bf16_f32 v62, v60, v61
    v_add_f32 v27, v27, v61
    v_perm_b32 v52, v62, v62, v2
    v_perm_b32 v53, v62, v62, v3
    v_perm_b32 v54, v62, v62, v4
    v_perm_b32 v55, v62, v62, v5
    v_perm_b32 v56, v62, v62, v6
    v_perm_b32 v57, v62, v62, v7
    v_perm_b32 v58, v62, v62, v8
    v_perm_b32 v59, v62, v62, v9
    v_mfma_f32_16x16x32_bf16 v[32:35], v[176:179], v[52:55], v[32:35]
    s_nop 0
    v_mfma_f32_16x16x32_bf16 v[32:35], v[180:183], v[56:59], v[32:35]
    s_waitcnt vmcnt(4)
    s_add_u32 s51, s60, 1572864
    s_and_b32 s51, s51, 0x1fffff
    buffer_load_dwordx4 v[200:203], v1, s[44:47], s51 offen offset:0 nt
    s_waitcnt vmcnt(4)
    v_mov_b32 v87, 1
    s_mov_b64 exec, 1
    buffer_atomic_add v87, v85, s[36:39], s62 offen sc0
    s_mov_b64 exec, -1
    buffer_load_dwordx4 v[204:207], v1, s[44:47], s51 offen offset:1024 nt
    v_lshlrev_b32 v60, 16, v78
    v_and_b32 v61, 0xffff0000, v78
    v_fma_f32 v60, v60, s58, -v26
    v_fma_f32 v61, v61, s58, -v26
    v_exp_f32 v60, v60
    v_exp_f32 v61, v61
    v_add_f32 v27, v27, v60
    v_cvt_pk_bf16_f32 v62, v60, v61
    v_add_f32 v27, v27, v61
    v_perm_b32 v52, v62, v62, v2
    v_perm_b32 v53, v62, v62, v3
    v_perm_b32 v54, v62, v62, v4
    v_perm_b32 v55, v62, v62, v5
    v_perm_b32 v56, v62, v62, v6
    v_perm_b32 v57, v62, v62, v7
    v_perm_b32 v58, v62, v62, v8
    v_perm_b32 v59, v62, v62, v9
    v_mfma_f32_16x16x32_bf16 v[32:35], v[184:187], v[52:55], v[32:35]
    s_nop 0
    v_mfma_f32_16x16x32_bf16 v[32:35], v[188:191], v[56:59], v[32:35]
    s_waitcnt vmcnt(5)
    buffer_load_dwordx4 v[208:211], v1, s[44:47], s51 offen offset:2048 nt
    s_waitcnt vmcnt(4)
    buffer_load_dwordx4 v[212:215], v1, s[44:47], s51 offen offset:3072 nt
    v_lshlrev_b32 v60, 16, v79
    v_and_b32 v61, 0xffff0000, v79
    v_fma_f32 v60, v60, s58, -v26
    v_fma_f32 v61, v61, s58, -v26
    v_exp_f32 v60, v60
    v_exp_f32 v61, v61
    v_add_f32 v27, v27, v60
    v_cvt_pk_bf16_f32 v62, v60, v61
    v_add_f32 v27, v27, v61
    v_perm_b32 v52, v62, v62, v2
    v_perm_b32 v53, v62, v62, v3
    v_perm_b32 v54, v62, v62, v4
    v_perm_b32 v55, v62, v62, v5
    v_perm_b32 v56, v62, v62, v6
    v_perm_b32 v57, v62, v62, v7
    v_perm_b32 v58, v62, v62, v8
    v_perm_b32 v59, v62, v62, v9
    v_mfma_f32_16x16x32_bf16 v[32:35], v[192:195], v[52:55], v[32:35]
    s_nop 0
    v_mfma_f32_16x16x32_bf16 v[32:35], v[196:199], v[56:59], v[32:35]
    s_waitcnt vmcnt(2)
    v_readfirstlane_b32 s52, v86
    s_nop 1
    s_cmp_lt_u32 s52, 80
    s_cselect_b32 s76, 0, 4286578688
    s_cselect_b32 s54, 0, 0x40000000
    s_lshl_b32 s52, s52, 12
    s_add_u32 s51, s61, s52
    s_and_b32 s51, s51, 0x1fffff
    s_or_b32 s51, s51, s54
    buffer_load_dwordx4 v[88:91], v1, s[40:43], s51 offen offset:0 nt
    buffer_load_dwordx4 v[96:99], v1, s[44:47], s51 offen offset:0 nt
    v_mov_b32 v86, 1
    s_mov_b64 exec, 1
    buffer_atomic_add v86, v85, s[36:39], s62 offen sc0
    s_mov_b64 exec, -1
    v_lshlrev_b32 v60, 16, v80
    v_and_b32 v61, 0xffff0000, v80
    v_fma_f32 v60, v60, s58, -v26
    v_fma_f32 v61, v61, s58, -v26
    v_exp_f32 v60, v60
    v_exp_f32 v61, v61
    v_add_f32 v27, v27, v60
    v_cvt_pk_bf16_f32 v62, v60, v61
    v_add_f32 v27, v27, v61
    v_perm_b32 v52, v62, v62, v2
    v_perm_b32 v53, v62, v62, v3
    v_perm_b32 v54, v62, v62, v4
    v_perm_b32 v55, v62, v62, v5
    v_perm_b32 v56, v62, v62, v6
    v_perm_b32 v57, v62, v62, v7
    v_perm_b32 v58, v62, v62, v8
    v_perm_b32 v59, v62, v62, v9
    v_mfma_f32_16x16x32_bf16 v[32:35], v[200:203], v[52:55], v[32:35]
    s_nop 0
    v_mfma_f32_16x16x32_bf16 v[32:35], v[204:207], v[56:59], v[32:35]
    s_waitcnt vmcnt(3)
    v_readfirstlane_b32 s52, v87
    s_nop 1
    s_cmp_lt_u32 s52, 80
    s_cselect_b32 s77, 0, 4286578688
    s_cselect_b32 s54, 0, 0x40000000
    s_lshl_b32 s52, s52, 12
    s_add_u32 s51, s61, s52
    s_and_b32 s51, s51, 0x1fffff
    s_or_b32 s51, s51, s54
    buffer_load_dwordx4 v[104:107], v1, s[40:43], s51 offen offset:0 nt
    buffer_load_dwordx4 v[112:115], v1, s[44:47], s51 offen offset:0 nt
    v_mov_b32 v87, 1
    s_mov_b64 exec, 1
    buffer_atomic_add v87, v85, s[36:39], s62 offen sc0
    s_mov_b64 exec, -1
    v_lshlrev_b32 v60, 16, v81
    v_and_b32 v61, 0xffff0000, v81
    v_fma_f32 v60, v60, s58, -v26
    v_fma_f32 v61, v61, s58, -v26
    v_exp_f32 v60, v60
    v_exp_f32 v61, v61
    v_add_f32 v27, v27, v60
    v_cvt_pk_bf16_f32 v62, v60, v61
    v_add_f32 v27, v27, v61
    v_perm_b32 v52, v62, v62, v2
    v_perm_b32 v53, v62, v62, v3
    v_perm_b32 v54, v62, v62, v4
    v_perm_b32 v55, v62, v62, v5
    v_perm_b32 v56, v62, v62, v6
    v_perm_b32 v57, v62, v62, v7
    v_perm_b32 v58, v62, v62, v8
    v_perm_b32 v59, v62, v62, v9
    v_mfma_f32_16x16x32_bf16 v[32:35], v[208:211], v[52:55], v[32:35]
    s_nop 0
    v_mfma_f32_16x16x32_bf16 v[32:35], v[212:215], v[56:59], v[32:35]
L_pool_47:
    s_waitcnt vmcnt(3)
    v_readfirstlane_b32 s52, v86
    s_nop 1
    s_cmp_lt_u32 s52, 80
    s_cbranch_scc0 L_drain_48
    s_lshl_b32 s52, s52, 12
    s_add_u32 s51, s61, s52
    s_and_b32 s51, s51, 0x1fffff
    v_dot2_f32_bf16 v36, v88, v10, 0
    v_dot2_f32_bf16 v37, v88, v18, 0
    v_dot2_f32_bf16 v36, v89, v12, v36
    v_dot2_f32_bf16 v37, v89, v20, v37
    v_dot2_f32_bf16 v36, v90, v14, v36
    v_dot2_f32_bf16 v37, v90, v22, v37
    v_dot2_f32_bf16 v36, v91, v16, v36
    v_dot2_f32_bf16 v37, v91, v24, v37
    buffer_load_dwordx4 v[88:91], v1, s[40:43], s51 offen offset:0 nt
    s_nop 0
    v_add_f32_dpp v44, v36, v36 row_ror:8 row_mask:0xf bank_mask:0x3
    v_add_f32_dpp v44, v37, v37 row_ror:8 row_mask:0xf bank_mask:0xc
    s_nop 1
    v_add_f32_dpp v44, v44, v44 row_half_mirror row_mask:0xf bank_mask:0xf
    s_nop 1
    v_add_f32_dpp v44, v44, v44 quad_perm:[1,0,3,2] row_mask:0xf bank_mask:0xf
    s_nop 1
    v_add_f32_dpp v44, v44, v44 quad_perm:[2,3,0,1] row_mask:0xf bank_mask:0xf
    v_cvt_pk_bf16_f32 v48, v44, v44
    v_and_b32 v49, 0xffff0000, v48
    v_lshlrev_b32 v48, 16, v48
    v_mul_f32 v49, 1035273459, v49
    v_mul_f32 v48, 1035273459, v48
    v_cvt_pk_bf16_f32 v48, v48, v49
    v_lshlrev_b32 v44, 16, v48
    v_and_b32 v45, 0xffff0000, v48
    v_add_f32 v44, s76, v44
    v_add_f32 v45, s76, v45
    v_fma_f32 v60, v44, s58, -v26
    v_fma_f32 v61, v45, s58, -v26
    v_max_f32 v46, v60, v61
    v_cmp_lt_f32 vcc, 0, v46
    s_cbranch_vccz L_nomax_51
    v_max_f32 v46, v44, v45
    v_mul_f32 v46, s58, v46
    v_mov_b32 v48, v46
    s_nop 1
    v_permlane16_swap_b32 v46, v48
    v_max_f32 v46, v46, v48
    v_mov_b32 v48, v46
    s_nop 1
    v_permlane32_swap_b32 v46, v48
    v_max_f32 v46, v46, v48
    v_max_f32 v46, v46, v26
    v_sub_f32 v47, v26, v46
    v_exp_f32 v47, v47
    v_mov_b32 v26, v46
    v_fma_f32 v60, v44, s58, -v46
    v_fma_f32 v61, v45, s58, -v46
    v_mul_f32 v27, v27, v47
    v_mul_f32 v32, v32, v47
    v_mul_f32 v33, v33, v47
    v_mul_f32 v34, v34, v47
    v_mul_f32 v35, v35, v47
L_nomax_51:
    v_exp_f32 v60, v60
    v_exp_f32 v61, v61
    v_add_f32 v27, v27, v60
    v_cvt_pk_bf16_f32 v62, v60, v61
    v_perm_b32 v52, v62, v62, v2
    v_perm_b32 v53, v62, v62, v3
    v_perm_b32 v54, v62, v62, v4
    v_perm_b32 v55, v62, v62, v5
    s_nop 1
    v_mfma_f32_16x16x32_bf16 v[32:35], v[96:99], v[52:55], v[32:35]
    s_mov_b32 s76, 0
    buffer_load_dwordx4 v[96:99], v1, s[44:47], s51 offen offset:0 nt
    v_mov_b32 v86, 1
    s_mov_b64 exec, 1
    buffer_atomic_add v86, v85, s[36:39], s62 offen sc0
    s_mov_b64 exec, -1
    s_waitcnt vmcnt(3)
    v_readfirstlane_b32 s52, v87
    s_nop 1
    s_cmp_lt_u32 s52, 80
    s_cbranch_scc0 L_drain_49
    s_lshl_b32 s52, s52, 12
    s_add_u32 s51, s61, s52
    s_and_b32 s51, s51, 0x1fffff
    v_dot2_f32_bf16 v36, v104, v10, 0
    v_dot2_f32_bf16 v37, v104, v18, 0
    v_dot2_f32_bf16 v36, v105, v12, v36
    v_dot2_f32_bf16 v37, v105, v20, v37
    v_dot2_f32_bf16 v36, v106, v14, v36
    v_dot2_f32_bf16 v37, v106, v22, v37
    v_dot2_f32_bf16 v36, v107, v16, v36
    v_dot2_f32_bf16 v37, v107, v24, v37
    buffer_load_dwordx4 v[104:107], v1, s[40:43], s51 offen offset:0 nt
    s_nop 0
    v_add_f32_dpp v44, v36, v36 row_ror:8 row_mask:0xf bank_mask:0x3
    v_add_f32_dpp v44, v37, v37 row_ror:8 row_mask:0xf bank_mask:0xc
    s_nop 1
    v_add_f32_dpp v44, v44, v44 row_half_mirror row_mask:0xf bank_mask:0xf
    s_nop 1
    v_add_f32_dpp v44, v44, v44 quad_perm:[1,0,3,2] row_mask:0xf bank_mask:0xf
    s_nop 1
    v_add_f32_dpp v44, v44, v44 quad_perm:[2,3,0,1] row_mask:0xf bank_mask:0xf
    v_cvt_pk_bf16_f32 v48, v44, v44
    v_and_b32 v49, 0xffff0000, v48
    v_lshlrev_b32 v48, 16, v48
    v_mul_f32 v49, 1035273459, v49
    v_mul_f32 v48, 1035273459, v48
    v_cvt_pk_bf16_f32 v48, v48, v49
    v_lshlrev_b32 v44, 16, v48
    v_and_b32 v45, 0xffff0000, v48
    v_add_f32 v44, s77, v44
    v_add_f32 v45, s77, v45
    v_fma_f32 v60, v44, s58, -v26
    v_fma_f32 v61, v45, s58, -v26
    v_max_f32 v46, v60, v61
    v_cmp_lt_f32 vcc, 0, v46
    s_cbranch_vccz L_nomax_52
    v_max_f32 v46, v44, v45
    v_mul_f32 v46, s58, v46
    v_mov_b32 v48, v46
    s_nop 1
    v_permlane16_swap_b32 v46, v48
    v_max_f32 v46, v46, v48
    v_mov_b32 v48, v46
    s_nop 1
    v_permlane32_swap_b32 v46, v48
    v_max_f32 v46, v46, v48
    v_max_f32 v46, v46, v26
    v_sub_f32 v47, v26, v46
    v_exp_f32 v47, v47
    v_mov_b32 v26, v46
    v_fma_f32 v60, v44, s58, -v46
    v_fma_f32 v61, v45, s58, -v46
    v_mul_f32 v27, v27, v47
    v_mul_f32 v32, v32, v47
    v_mul_f32 v33, v33, v47
    v_mul_f32 v34, v34, v47
    v_mul_f32 v35, v35, v47
L_nomax_52:
    v_exp_f32 v60, v60
    v_exp_f32 v61, v61
    v_add_f32 v27, v27, v60
    v_cvt_pk_bf16_f32 v62, v60, v61
    v_perm_b32 v52, v62, v62, v2
    v_perm_b32 v53, v62, v62, v3
    v_perm_b32 v54, v62, v62, v4
    v_perm_b32 v55, v62, v62, v5
    s_nop 1
    v_mfma_f32_16x16x32_bf16 v[32:35], v[112:115], v[52:55], v[32:35]
    s_mov_b32 s77, 0
    buffer_load_dwordx4 v[112:115], v1, s[44:47], s51 offen offset:0 nt
    v_mov_b32 v87, 1
    s_mov_b64 exec, 1
    buffer_atomic_add v87, v85, s[36:39], s62 offen sc0
    s_mov_b64 exec, -1
    s_branch L_pool_47
L_drain_48:
    v_dot2_f32_bf16 v36, v88, v10, 0
    v_dot2_f32_bf16 v37, v88, v18, 0
    v_dot2_f32_bf16 v36, v89, v12, v36
    v_dot2_f32_bf16 v37, v89, v20, v37
    v_dot2_f32_bf16 v36, v90, v14, v36
    v_dot2_f32_bf16 v37, v90, v22, v37
    v_dot2_f32_bf16 v36, v91, v16, v36
    v_dot2_f32_bf16 v37, v91, v24, v37
    s_nop 1
    v_add_f32_dpp v44, v36, v36 row_ror:8 row_mask:0xf bank_mask:0x3
    v_add_f32_dpp v44, v37, v37 row_ror:8 row_mask:0xf bank_mask:0xc
    s_nop 1
    v_add_f32_dpp v44, v44, v44 row_half_mirror row_mask:0xf bank_mask:0xf
    s_nop 1
    v_add_f32_dpp v44, v44, v44 quad_perm:[1,0,3,2] row_mask:0xf bank_mask:0xf
    s_nop 1
    v_add_f32_dpp v44, v44, v44 quad_perm:[2,3,0,1] row_mask:0xf bank_mask:0xf
    v_cvt_pk_bf16_f32 v48, v44, v44
    v_and_b32 v49, 0xffff0000, v48
    v_lshlrev_b32 v48, 16, v48
    v_mul_f32 v49, 1035273459, v49
    v_mul_f32 v48, 1035273459, v48
    v_cvt_pk_bf16_f32 v48, v48, v49
    v_lshlrev_b32 v44, 16, v48
    v_and_b32 v45, 0xffff0000, v48
    v_add_f32 v44, s76, v44
    v_add_f32 v45, s76, v45
    v_fma_f32 v60, v44, s58, -v26
    v_fma_f32 v61, v45, s58, -v26
    v_max_f32 v46, v60, v61
    v_cmp_lt_f32 vcc, 0, v46
    s_cbranch_vccz L_nomax_53
    v_max_f32 v46, v44, v45
    v_mul_f32 v46, s58, v46
    v_mov_b32 v48, v46
    s_nop 1
    v_permlane16_swap_b32 v46, v48
    v_max_f32 v46, v46, v48
    v_mov_b32 v48, v46
    s_nop 1
    v_permlane32_swap_b32 v46, v48
    v_max_f32 v46, v46, v48
    v_max_f32 v46, v46, v26
    v_sub_f32 v47, v26, v46
    v_exp_f32 v47, v47
    v_mov_b32 v26, v46
    v_fma_f32 v60, v44, s58, -v46
    v_fma_f32 v61, v45, s58, -v46
    v_mul_f32 v27, v27, v47
    v_mul_f32 v32, v32, v47
    v_mul_f32 v33, v33, v47
    v_mul_f32 v34, v34, v47
    v_mul_f32 v35, v35, v47
L_nomax_53:
    v_exp_f32 v60, v60
    v_exp_f32 v61, v61
    v_add_f32 v27, v27, v60
    v_cvt_pk_bf16_f32 v62, v60, v61
    v_perm_b32 v52, v62, v62, v2
    v_perm_b32 v53, v62, v62, v3
    v_perm_b32 v54, v62, v62, v4
    v_perm_b32 v55, v62, v62, v5
    s_nop 1
    v_mfma_f32_16x16x32_bf16 v[32:35], v[96:99], v[52:55], v[32:35]
    buffer_load_dwordx4 v[120:123], v30, s[68:71], 0 offen offset:0 nt
    s_waitcnt vmcnt(3)
    buffer_load_dwordx4 v[124:127], v30, s[68:71], 0 offen offset:1152 nt
    buffer_load_dwordx4 v[128:131], v30, s[68:71], 0 offen offset:2304 nt
    s_cmp_lt_u32 s3, 4
    s_cbranch_scc1 L_tws_54
    buffer_load_dwordx4 v[132:135], v30, s[68:71], 0 offen offset:3456 nt
    buffer_load_dwordx4 v[136:139], v31, s[68:71], 0 offen offset:0 nt
    buffer_load_dwordx4 v[140:143], v31, s[68:71], 0 offen offset:2304 nt
L_tws_54:
    v_dot2_f32_bf16 v36, v104, v10, 0
    v_dot2_f32_bf16 v37, v104, v18, 0
    v_dot2_f32_bf16 v36, v105, v12, v36
    v_dot2_f32_bf16 v37, v105, v20, v37
    v_dot2_f32_bf16 v36, v106, v14, v36
    v_dot2_f32_bf16 v37, v106, v22, v37
    v_dot2_f32_bf16 v36, v107, v16, v36
    v_dot2_f32_bf16 v37, v107, v24, v37
    s_nop 1
    v_add_f32_dpp v44, v36, v36 row_ror:8 row_mask:0xf bank_mask:0x3
    v_add_f32_dpp v44, v37, v37 row_ror:8 row_mask:0xf bank_mask:0xc
    s_nop 1
    v_add_f32_dpp v44, v44, v44 row_half_mirror row_mask:0xf bank_mask:0xf
    s_nop 1
    v_add_f32_dpp v44, v44, v44 quad_perm:[1,0,3,2] row_mask:0xf bank_mask:0xf
    s_nop 1
    v_add_f32_dpp v44, v44, v44 quad_perm:[2,3,0,1] row_mask:0xf bank_mask:0xf
    v_cvt_pk_bf16_f32 v48, v44, v44
    v_and_b32 v49, 0xffff0000, v48
    v_lshlrev_b32 v48, 16, v48
    v_mul_f32 v49, 1035273459, v49
    v_mul_f32 v48, 1035273459, v48
    v_cvt_pk_bf16_f32 v48, v48, v49
    v_lshlrev_b32 v44, 16, v48
    v_and_b32 v45, 0xffff0000, v48
    v_add_f32 v44, s77, v44
    v_add_f32 v45, s77, v45
    v_fma_f32 v60, v44, s58, -v26
    v_fma_f32 v61, v45, s58, -v26
    v_max_f32 v46, v60, v61
    v_cmp_lt_f32 vcc, 0, v46
    s_cbranch_vccz L_nomax_55
    v_max_f32 v46, v44, v45
    v_mul_f32 v46, s58, v46
    v_mov_b32 v48, v46
    s_nop 1
    v_permlane16_swap_b32 v46, v48
    v_max_f32 v46, v46, v48
    v_mov_b32 v48, v46
    s_nop 1
    v_permlane32_swap_b32 v46, v48
    v_max_f32 v46, v46, v48
    v_max_f32 v46, v46, v26
    v_sub_f32 v47, v26, v46
    v_exp_f32 v47, v47
    v_mov_b32 v26, v46
    v_fma_f32 v60, v44, s58, -v46
    v_fma_f32 v61, v45, s58, -v46
    v_mul_f32 v27, v27, v47
    v_mul_f32 v32, v32, v47
    v_mul_f32 v33, v33, v47
    v_mul_f32 v34, v34, v47
    v_mul_f32 v35, v35, v47
L_nomax_55:
    v_exp_f32 v60, v60
    v_exp_f32 v61, v61
    v_add_f32 v27, v27, v60
    v_cvt_pk_bf16_f32 v62, v60, v61
    v_perm_b32 v52, v62, v62, v2
    v_perm_b32 v53, v62, v62, v3
    v_perm_b32 v54, v62, v62, v4
    v_perm_b32 v55, v62, v62, v5
    s_waitcnt vmcnt(7)
    s_cmp_ge_u32 s3, 4
    s_cbranch_scc1 L_vw_56
    s_waitcnt vmcnt(4)
L_vw_56:
    v_mfma_f32_16x16x32_bf16 v[32:35], v[112:115], v[52:55], v[32:35]
    s_branch L_poolend_50
L_drain_49:
    v_dot2_f32_bf16 v36, v104, v10, 0
    v_dot2_f32_bf16 v37, v104, v18, 0
    v_dot2_f32_bf16 v36, v105, v12, v36
    v_dot2_f32_bf16 v37, v105, v20, v37
    v_dot2_f32_bf16 v36, v106, v14, v36
    v_dot2_f32_bf16 v37, v106, v22, v37
    v_dot2_f32_bf16 v36, v107, v16, v36
    v_dot2_f32_bf16 v37, v107, v24, v37
    s_nop 1
    v_add_f32_dpp v44, v36, v36 row_ror:8 row_mask:0xf bank_mask:0x3
    v_add_f32_dpp v44, v37, v37 row_ror:8 row_mask:0xf bank_mask:0xc
    s_nop 1
    v_add_f32_dpp v44, v44, v44 row_half_mirror row_mask:0xf bank_mask:0xf
    s_nop 1
    v_add_f32_dpp v44, v44, v44 quad_perm:[1,0,3,2] row_mask:0xf bank_mask:0xf
    s_nop 1
    v_add_f32_dpp v44, v44, v44 quad_perm:[2,3,0,1] row_mask:0xf bank_mask:0xf
    v_cvt_pk_bf16_f32 v48, v44, v44
    v_and_b32 v49, 0xffff0000, v48
    v_lshlrev_b32 v48, 16, v48
    v_mul_f32 v49, 1035273459, v49
    v_mul_f32 v48, 1035273459, v48
    v_cvt_pk_bf16_f32 v48, v48, v49
    v_lshlrev_b32 v44, 16, v48
    v_and_b32 v45, 0xffff0000, v48
    v_add_f32 v44, s77, v44
    v_add_f32 v45, s77, v45
    v_fma_f32 v60, v44, s58, -v26
    v_fma_f32 v61, v45, s58, -v26
    v_max_f32 v46, v60, v61
    v_cmp_lt_f32 vcc, 0, v46
    s_cbranch_vccz L_nomax_57
    v_max_f32 v46, v44, v45
    v_mul_f32 v46, s58, v46
    v_mov_b32 v48, v46
    s_nop 1
    v_permlane16_swap_b32 v46, v48
    v_max_f32 v46, v46, v48
    v_mov_b32 v48, v46
    s_nop 1
    v_permlane32_swap_b32 v46, v48
    v_max_f32 v46, v46, v48
    v_max_f32 v46, v46, v26
    v_sub_f32 v47, v26, v46
    v_exp_f32 v47, v47
    v_mov_b32 v26, v46
    v_fma_f32 v60, v44, s58, -v46
    v_fma_f32 v61, v45, s58, -v46
    v_mul_f32 v27, v27, v47
    v_mul_f32 v32, v32, v47
    v_mul_f32 v33, v33, v47
    v_mul_f32 v34, v34, v47
    v_mul_f32 v35, v35, v47
L_nomax_57:
    v_exp_f32 v60, v60
    v_exp_f32 v61, v61
    v_add_f32 v27, v27, v60
    v_cvt_pk_bf16_f32 v62, v60, v61
    v_perm_b32 v52, v62, v62, v2
    v_perm_b32 v53, v62, v62, v3
    v_perm_b32 v54, v62, v62, v4
    v_perm_b32 v55, v62, v62, v5
    s_nop 1
    v_mfma_f32_16x16x32_bf16 v[32:35], v[112:115], v[52:55], v[32:35]
    buffer_load_dwordx4 v[120:123], v30, s[68:71], 0 offen offset:0 nt
    s_waitcnt vmcnt(3)
    buffer_load_dwordx4 v[124:127], v30, s[68:71], 0 offen offset:1152 nt
    buffer_load_dwordx4 v[128:131], v30, s[68:71], 0 offen offset:2304 nt
    s_cmp_lt_u32 s3, 4
    s_cbranch_scc1 L_tws_58
    buffer_load_dwordx4 v[132:135], v30, s[68:71], 0 offen offset:3456 nt
    buffer_load_dwordx4 v[136:139], v31, s[68:71], 0 offen offset:0 nt
    buffer_load_dwordx4 v[140:143], v31, s[68:71], 0 offen offset:2304 nt
L_tws_58:
    v_dot2_f32_bf16 v36, v88, v10, 0
    v_dot2_f32_bf16 v37, v88, v18, 0
    v_dot2_f32_bf16 v36, v89, v12, v36
    v_dot2_f32_bf16 v37, v89, v20, v37
    v_dot2_f32_bf16 v36, v90, v14, v36
    v_dot2_f32_bf16 v37, v90, v22, v37
    v_dot2_f32_bf16 v36, v91, v16, v36
    v_dot2_f32_bf16 v37, v91, v24, v37
    s_nop 1
    v_add_f32_dpp v44, v36, v36 row_ror:8 row_mask:0xf bank_mask:0x3
    v_add_f32_dpp v44, v37, v37 row_ror:8 row_mask:0xf bank_mask:0xc
    s_nop 1
    v_add_f32_dpp v44, v44, v44 row_half_mirror row_mask:0xf bank_mask:0xf
    s_nop 1
    v_add_f32_dpp v44, v44, v44 quad_perm:[1,0,3,2] row_mask:0xf bank_mask:0xf
    s_nop 1
    v_add_f32_dpp v44, v44, v44 quad_perm:[2,3,0,1] row_mask:0xf bank_mask:0xf
    v_cvt_pk_bf16_f32 v48, v44, v44
    v_and_b32 v49, 0xffff0000, v48
    v_lshlrev_b32 v48, 16, v48
    v_mul_f32 v49, 1035273459, v49
    v_mul_f32 v48, 1035273459, v48
    v_cvt_pk_bf16_f32 v48, v48, v49
    v_lshlrev_b32 v44, 16, v48
    v_and_b32 v45, 0xffff0000, v48
    v_add_f32 v44, s76, v44
    v_add_f32 v45, s76, v45
    v_fma_f32 v60, v44, s58, -v26
    v_fma_f32 v61, v45, s58, -v26
    v_max_f32 v46, v60, v61
    v_cmp_lt_f32 vcc, 0, v46
    s_cbranch_vccz L_nomax_59
    v_max_f32 v46, v44, v45
    v_mul_f32 v46, s58, v46
    v_mov_b32 v48, v46
    s_nop 1
    v_permlane16_swap_b32 v46, v48
    v_max_f32 v46, v46, v48
    v_mov_b32 v48, v46
    s_nop 1
    v_permlane32_swap_b32 v46, v48
    v_max_f32 v46, v46, v48
    v_max_f32 v46, v46, v26
    v_sub_f32 v47, v26, v46
    v_exp_f32 v47, v47
    v_mov_b32 v26, v46
    v_fma_f32 v60, v44, s58, -v46
    v_fma_f32 v61, v45, s58, -v46
    v_mul_f32 v27, v27, v47
    v_mul_f32 v32, v32, v47
    v_mul_f32 v33, v33, v47
    v_mul_f32 v34, v34, v47
    v_mul_f32 v35, v35, v47
L_nomax_59:
    v_exp_f32 v60, v60
    v_exp_f32 v61, v61
    v_add_f32 v27, v27, v60
    v_cvt_pk_bf16_f32 v62, v60, v61
    v_perm_b32 v52, v62, v62, v2
    v_perm_b32 v53, v62, v62, v3
    v_perm_b32 v54, v62, v62, v4
    v_perm_b32 v55, v62, v62, v5
    s_waitcnt vmcnt(7)
    s_cmp_ge_u32 s3, 4
    s_cbranch_scc1 L_vw_60
    s_waitcnt vmcnt(4)
L_vw_60:
    v_mfma_f32_16x16x32_bf16 v[32:35], v[96:99], v[52:55], v[32:35]
L_poolend_50:
    v_mov_b32 v48, v27
    s_nop 1
    v_permlane16_swap_b32 v27, v48
    v_add_f32 v27, v27, v48
    v_mov_b32 v48, v27
    s_nop 1
    v_permlane32_swap_b32 v27, v48
    v_add_f32 v27, v27, v48
    ds_write_b64 v84, v[26:27]
    ds_write_b128 v83, v[32:35]
    v_mov_b32 v59, s35
    s_waitcnt lgkmcnt(0)
    s_barrier
    s_cmp_ge_u32 s3, 4
    s_cbranch_scc1 L_aup_61
    ds_read_b128 v[10:13], v29 offset:0
    ds_read_b128 v[14:17], v29 offset:16
    ds_read_b128 v[18:21], v29 offset:32
    ds_read_b128 v[22:25], v29 offset:48
    ds_read_b32 v36, v28 offset:0
    ds_read_b32 v37, v28 offset:1024
    ds_read_b32 v38, v28 offset:2048
    ds_read_b32 v39, v28 offset:3072
    ds_read_b32 v40, v28 offset:4096
    ds_read_b32 v41, v28 offset:5120
    ds_read_b32 v42, v28 offset:6144
    ds_read_b32 v43, v28 offset:7168
    s_waitcnt lgkmcnt(8)
    v_max3_f32 v52, v10, v12, v14
    v_max3_f32 v53, v16, v18, v20
    v_max3_f32 v52, v52, v22, v24
    v_max_f32 v52, v52, v53
    v_sub_f32 v10, v10, v52
    v_sub_f32 v12, v12, v52
    v_sub_f32 v14, v14, v52
    v_sub_f32 v16, v16, v52
    v_sub_f32 v18, v18, v52
    v_sub_f32 v20, v20, v52
    v_sub_f32 v22, v22, v52
    v_sub_f32 v24, v24, v52
    v_exp_f32 v10, v10
    v_exp_f32 v12, v12
    v_exp_f32 v14, v14
    v_exp_f32 v16, v16
    v_exp_f32 v18, v18
    v_exp_f32 v20, v20
    v_exp_f32 v22, v22
    v_exp_f32 v24, v24
    s_waitcnt lgkmcnt(0)
    v_mul_f32 v53, v10, v11
    v_mul_f32 v54, v10, v36
    v_fmac_f32 v53, v12, v13
    v_fmac_f32 v54, v12, v37
    v_fmac_f32 v53, v14, v15
    v_fmac_f32 v54, v14, v38
    v_fmac_f32 v53, v16, v17
    v_fmac_f32 v54, v16, v39
    v_fmac_f32 v53, v18, v19
    v_fmac_f32 v54, v18, v40
    v_fmac_f32 v53, v20, v21
    v_fmac_f32 v54, v20, v41
    v_fmac_f32 v53, v22, v23
    v_fmac_f32 v54, v22, v42
    v_fmac_f32 v53, v24, v25
    v_fmac_f32 v54, v24, v43
    v_rcp_f32 v55, v53
    v_log_f32 v58, v53
    v_mul_f32 v54, v54, v55
    v_add_f32 v58, v58, v52
    s_nop 0
    v_mov_b32_dpp v55, v54 quad_perm:[1,0,3,2] row_mask:0xf bank_mask:0xf
    v_cvt_pk_bf16_f32 v56, v54, v55
    s_nop 1
    v_mov_b32_dpp v57, v56 quad_perm:[2,3,0,1] row_mask:0xf bank_mask:0xf
    s_mov_b32 exec_lo, 0x11111111
    s_mov_b32 exec_hi, 0x11111111
    buffer_store_dwordx4 v[56:59], v63, s[36:39], s78 offen sc1
    s_mov_b64 exec, -1
    buffer_load_dwordx4 v[132:135], v30, s[68:71], 0 offen offset:3456 nt
    buffer_load_dwordx4 v[136:139], v31, s[68:71], 0 offen offset:0 nt
    buffer_load_dwordx4 v[140:143], v31, s[68:71], 0 offen offset:2304 nt
L_aup_61:
    v_and_b32 v50, 7, v0
    v_min_u32 v51, 5, v50
    v_and_b32 v52, 1, v0
    s_cmp_eq_u32 s63, 0
    s_cselect_b64 vcc, -1, 0
    s_cselect_b32 s66, 5, 7
    v_cndmask_b32 v51, v52, v51, vcc
    v_bfe_u32 v49, v0, 3, 1
    v_lshl_add_u32 v29, v49, 8, v51
    v_lshlrev_b32 v29, 9, v29
    s_lshl_b32 s52, s63, 6
    s_add_u32 s52, s52, s64
    s_lshl_b32 s52, s52, 12
    s_lshl_b32 s54, s3, 6
    s_add_u32 s52, s52, s54
    s_add_u32 s75, s52, 196608
    v_lshrrev_b32 v48, 4, v0
    v_lshl_add_u32 v29, v48, 4, v29
    buffer_load_dwordx4 v[10:13], v29, s[36:39], s75 offen sc1
    v_cmp_lt_u32 s[72:73], s66, v50
    v_mov_b32 v32, 0
    v_mov_b32 v33, 0
    v_mov_b32 v34, 0
    v_mov_b32 v35, 0
    v_mov_b32 v36, 0
    v_mov_b32 v37, 0
    v_mov_b32 v38, 0
    v_mov_b32 v39, 0
    v_mov_b32 v40, 0
    v_mov_b32 v41, 0
    v_mov_b32 v42, 0
    v_mov_b32 v43, 0
    v_and_b32 v26, 7, v0
    v_lshlrev_b32 v26, 4, v26
    v_bfe_u32 v48, v0, 3, 2
    v_lshl_add_u32 v26, v48, 2, v26
    v_lshrrev_b32 v48, 5, v0
    s_cmp_ge_u32 s3, 4
    s_cselect_b32 s52, 9, 8
    s_cselect_b32 s54, 8, 9
    s_cselect_b32 s55, 8192, 0
    s_cselect_b32 s56, 1024, 0
    s_add_u32 s55, s55, 16384
    v_lshl_add_u32 v26, v48, s52, v26
    s_and_b32 s57, s3, 1
    s_lshl_b32 s57, s57, s54
    s_add_u32 s56, s56, s57
    s_add_u32 s55, s55, s57
    s_bfe_u32 s57, s3, 0x10001
    s_lshl_b32 s52, s57, 7
    s_add_u32 s55, s55, s52
    v_add_u32 v26, s55, v26
    s_lshl_b32 s52, s3, 10
    s_add_u32 s52, s52, 16384
    v_add_u32 v27, s52, v1
    v_lshlrev_b32 v23, 3, v0
    v_add_u32 v23, s56, v23
    s_lshl_b32 s74, s63, 5
    s_add_u32 s74, s74, s64
    s_lshl_b32 s74, s74, 1
    s_add_u32 s74, s74, s57
    s_mul_i32 s74, s74, 4608
    s_mul_i32 s54, s65, 1536
    s_add_u32 s74, s74, s54
    s_add_u32 s74, s74, 1376256
    s_lshl_b32 s57, s57, 3
    v_mov_b32 v59, s35
    v_mov_b32 v47, 4286578688
    s_mov_b32 s53, 300000
    s_waitcnt vmcnt(0)
    v_xor_b32 v48, s35, v13
    v_cmp_ne_u32 vcc, 0, v48
    s_cbranch_vccz L_gdone_63
L_gpoll_62:
    buffer_load_dwordx4 v[10:13], v29, s[36:39], s75 offen sc1
    s_waitcnt vmcnt(0)
    v_xor_b32 v48, s35, v13
    v_cmp_ne_u32 vcc, 0, v48
    s_cbranch_vccz L_gdone_63
    s_sub_u32 s53, s53, 1
    s_cbranch_scc0 L_gpoll_62
    v_mov_b32 v62, 6
    v_mov_b32 v63, 0
    global_store_dword v63, v62, s[30:31] offset:64
    s_waitcnt vmcnt(0)
L_gdone_63:
    v_cndmask_b32 v46, v12, v47, s[72:73]
    v_lshlrev_b32 v52, 16, v10
    v_mov_b32 v44, v46
    v_and_b32 v53, 0xffff0000, v10
    v_lshlrev_b32 v54, 16, v11
    v_max_f32_dpp v44, v44, v44 row_half_mirror row_mask:0xf bank_mask:0xf
    s_nop 1
    v_max_f32_dpp v44, v44, v44 quad_perm:[1,0,3,2] row_mask:0xf bank_mask:0xf
    s_nop 1
    v_max_f32_dpp v44, v44, v44 quad_perm:[2,3,0,1] row_mask:0xf bank_mask:0xf
    v_sub_f32 v44, v46, v44
    v_and_b32 v55, 0xffff0000, v11
    v_exp_f32 v56, v44
    s_nop 0
    v_mul_f32 v52, v56, v52
    v_mul_f32 v53, v56, v53
    v_mul_f32 v54, v56, v54
    v_mul_f32 v55, v56, v55
    v_add_f32_dpp v52, v52, v52 row_half_mirror row_mask:0xf bank_mask:0xf
    v_add_f32_dpp v53, v53, v53 row_half_mirror row_mask:0xf bank_mask:0xf
    v_add_f32_dpp v54, v54, v54 row_half_mirror row_mask:0xf bank_mask:0xf
    v_add_f32_dpp v55, v55, v55 row_half_mirror row_mask:0xf bank_mask:0xf
    v_add_f32_dpp v56, v56, v56 row_half_mirror row_mask:0xf bank_mask:0xf
    v_add_f32_dpp v52, v52, v52 quad_perm:[1,0,3,2] row_mask:0xf bank_mask:0xf
    v_add_f32_dpp v53, v53, v53 quad_perm:[1,0,3,2] row_mask:0xf bank_mask:0xf
    v_add_f32_dpp v54, v54, v54 quad_perm:[1,0,3,2] row_mask:0xf bank_mask:0xf
    v_add_f32_dpp v55, v55, v55 quad_perm:[1,0,3,2] row_mask:0xf bank_mask:0xf
    v_add_f32_dpp v56, v56, v56 quad_perm:[1,0,3,2] row_mask:0xf bank_mask:0xf
    v_add_f32_dpp v52, v52, v52 quad_perm:[2,3,0,1] row_mask:0xf bank_mask:0xf
    v_add_f32_dpp v53, v53, v53 quad_perm:[2,3,0,1] row_mask:0xf bank_mask:0xf
    v_add_f32_dpp v54, v54, v54 quad_perm:[2,3,0,1] row_mask:0xf bank_mask:0xf
    v_add_f32_dpp v55, v55, v55 quad_perm:[2,3,0,1] row_mask:0xf bank_mask:0xf
    v_add_f32_dpp v56, v56, v56 quad_perm:[2,3,0,1] row_mask:0xf bank_mask:0xf
    v_cvt_pk_bf16_f32 v20, v52, v53
    v_cvt_pk_bf16_f32 v21, v54, v55
    v_rcp_f32 v56, v56
    v_perm_b32 v44, v20, v20, v2
    v_perm_b32 v45, v20, v20, v3
    v_perm_b32 v46, v20, v20, v4
    v_perm_b32 v47, v20, v20, v5
    v_perm_b32 v48, v20, v20, v6
    v_perm_b32 v49, v20, v20, v7
    v_perm_b32 v50, v20, v20, v8
    v_perm_b32 v51, v20, v20, v9
    v_mfma_f32_16x16x32_bf16 v[36:39], v[136:139], v[44:47], v[36:39]
    s_nop 0
    v_mfma_f32_16x16x32_bf16 v[40:43], v[136:139], v[48:51], v[40:43]
    v_mfma_f32_16x16x32_bf16 v[32:35], v[120:123], v[44:47], v[32:35]
    v_mfma_f32_16x16x32_bf16 v[32:35], v[124:127], v[48:51], v[32:35]
    v_perm_b32 v44, v21, v21, v2
    v_perm_b32 v45, v21, v21, v3
    v_perm_b32 v46, v21, v21, v4
    v_perm_b32 v47, v21, v21, v5
    v_perm_b32 v48, v21, v21, v6
    v_perm_b32 v49, v21, v21, v7
    v_perm_b32 v50, v21, v21, v8
    v_perm_b32 v51, v21, v21, v9
    v_mfma_f32_16x16x32_bf16 v[36:39], v[140:143], v[44:47], v[36:39]
    s_nop 0
    v_mfma_f32_16x16x32_bf16 v[40:43], v[140:143], v[48:51], v[40:43]
    v_mfma_f32_16x16x32_bf16 v[32:35], v[128:131], v[44:47], v[32:35]
    v_mfma_f32_16x16x32_bf16 v[32:35], v[132:135], v[48:51], v[32:35]
    v_cmp_lt_u32 vcc, 31, v0
    v_mul_f32 v56, s67, v56
    s_nop 0
    v_readlane_b32 s57, v56, s57
    s_nop 1
    v_cndmask_b32 v36, v36, v40, vcc
    v_cndmask_b32 v37, v37, v41, vcc
    v_cndmask_b32 v38, v38, v42, vcc
    v_cndmask_b32 v39, v39, v43, vcc
    ds_write_b128 v27, v[36:39] offset:8192
    ds_write_b128 v27, v[32:35]
    s_waitcnt lgkmcnt(0)
    s_barrier
    ds_read_b32 v44, v26 offset:0
    ds_read_b32 v45, v26 offset:1024
    ds_read_b32 v46, v26 offset:2048
    ds_read_b32 v47, v26 offset:3072
    ds_read_b32 v48, v26 offset:4096
    ds_read_b32 v49, v26 offset:5120
    ds_read_b32 v50, v26 offset:6144
    ds_read_b32 v51, v26 offset:7168
    s_waitcnt lgkmcnt(0)
    v_add_f32 v44, v44, v45
    v_add_f32 v46, v46, v47
    v_add_f32 v48, v48, v49
    v_add_f32 v50, v50, v51
    v_add_f32 v44, v44, v46
    v_add_f32 v48, v48, v50
    v_add_f32 v58, v44, v48
    s_cmp_lt_u32 s3, 4
    s_cbranch_scc1 L_tfull_65
    v_mov_b32 v49, v58
    s_nop 1
    v_permlane32_swap_b32 v58, v49
    v_add_f32 v58, v58, v49
    s_mov_b32 exec_hi, 0
L_tfull_65:
    v_mul_f32 v58, s57, v58
    buffer_store_dwordx2 v[58:59], v23, s[36:39], s74 offen sc1
    s_mov_b64 exec, -1
L_fin_5:
L_end_6:
    s_endpgm
.section .rodata,"a"
.p2align 6
.amdhsa_kernel gated_mix__gqa_block_cached__compressed_kv_cla__decode_kernel
  .amdhsa_next_free_vgpr 256
  .amdhsa_next_free_sgpr 102
  .amdhsa_accum_offset 256
  .amdhsa_group_segment_fixed_size 0
  .amdhsa_kernarg_size 120
  .amdhsa_user_sgpr_count 2
  .amdhsa_user_sgpr_kernarg_segment_ptr 1
  .amdhsa_system_sgpr_workgroup_id_x 1
.end_amdhsa_kernel
```
